```python
import torch

def _softmax(x, axis=-1):
    return torch.softmax(x, dim=axis)
def _gelu(x):
    return torch.nn.functional.gelu(x, approximate="tanh")
def _silu(x):
    return torch.nn.functional.silu(x)
def _sigmoid(x):
    return torch.sigmoid(x)
def _layernorm(x, axis=-1, eps=1e-5):
    m = x.mean(dim=axis, keepdim=True)
    v = x.var(dim=axis, keepdim=True, unbiased=False)
    return (x - m) / torch.sqrt(v + eps)
def _scatter_add(tgt, idx, src, axis=0):
    return tgt.clone().index_add_(axis, idx, src)
def _segment_sum(src, seg, n):
    out = torch.zeros((n,) + src.shape[1:], dtype=src.dtype)
    return out.index_add_(0, seg, src)
def _pad(x, pw):
    flat = tuple(v for pair in reversed(pw) for v in pair)
    return torch.nn.functional.pad(x, flat)

kernel_name = 'standalone__weight_only_int_quip__sampling'

def setup_inputs():

    _w = (lambda a: (lambda t: t.to(torch.bfloat16) if t.is_floating_point() else t)(torch.as_tensor(a)))
    B, S, D, F = 16, 4, 1024, 3584
    G = 32 if 32 > 0 else D
    D = (D // G) * G
    ng = D // G
    bits = 3 if 3 > 0 else 4
    qmax = 1 << bits
    qw = torch.randint(0, qmax, (D, F)).to(torch.int32)
    U, _ = (lambda *_a, **_k: torch.linalg.qr(*[torch.as_tensor(_x).float() for _x in _a], **_k))((lambda *s: torch.randn(*s, dtype=torch.bfloat16) * 0.05)(D, D))
    V, _ = (lambda *_a, **_k: torch.linalg.qr(*[torch.as_tensor(_x).float() for _x in _a], **_k))((lambda *s: torch.randn(*s, dtype=torch.bfloat16) * 0.05)(F, F))
    return {
        "x": _w((lambda *s: torch.randn(*s, dtype=torch.bfloat16) * 0.05)(B, S, D)),
        "qw": _w(qw),
        "scales": _w(torch.abs((lambda *s: torch.randn(*s, dtype=torch.bfloat16) * 0.05)(ng, F)) * 0.02 + 0.005),
        "zeros": _w(torch.full((ng, F), qmax / 2.0, dtype=float)),
        "U": _w(U.to(float)),
        "V": _w(V.to(float)),
    }

def reference(x, qw, scales, zeros, U, V):
    B, S, D = x.shape
    ng, F = scales.shape
    G = D // ng
    s = (lambda x, n, axis: torch.repeat_interleave(x, n, dim=axis))(scales, G, axis=0)
    z = (lambda x, n, axis: torch.repeat_interleave(x, n, dim=axis))(zeros, G, axis=0)
    wq = ((lambda x, dt: x.to(dt))(qw, x.dtype) - z) * s
    xr = torch.einsum("bsd,de->bse", x, U)
    h  = torch.einsum("bse,ef->bsf", xr, wq)
    y  = torch.einsum("bsf,fg->bsg", h, V)
    return y
```

```asm
; @launch grid=(256,1,1) block=(512,1,1) lds=163840
.amdgcn_target "amdgcn-amd-amdhsa--gfx950"
.text
.globl standalone__weight_only_int_quip__sampling_kernel
.p2align 8
.type standalone__weight_only_int_quip__sampling_kernel,@function
standalone__weight_only_int_quip__sampling_kernel:
    s_load_dwordx2 s[48:49], s[0:1], 64
    s_load_dwordx2 s[28:29], s[0:1], 8
    s_lshr_b32 s5, s2, 3
    s_cmp_ge_u32 s5, 14
    s_cselect_b32 s8, 32, 16
    s_cselect_b32 s9, 0, 24
    s_load_dwordx2 s[36:37], s[0:1], s8
    s_load_dwordx2 s[40:41], s[0:1], s9
    v_lshrrev_b32 v2, 6, v0
    v_and_b32 v1, 63, v0
    s_and_b32 s4, s2, 7
    v_readfirstlane_b32 s3, v2
    s_mov_b32 s30, 0xe00000
    s_mov_b32 s31, 0x00020000
    s_mov_b32 s50, 0x600000
    s_mov_b32 s51, 0x00020000
    v_and_b32 v3, 15, v1
    v_lshrrev_b32 v4, 4, v1
    v_lshlrev_b32 v98, 4, v1
    v_mov_b32 v6, 0
    s_cmp_lt_u32 s5, 14
    s_cbranch_scc1 ROLE_B
    s_sub_u32 s5, s5, 14
    s_cmp_ge_u32 s5, 16
    s_cbranch_scc1 C_HELP
    s_mov_b32 s38, 0x200000
    s_mov_b32 s39, 0x00020000
    s_mov_b32 s42, 0x20000
    s_mov_b32 s43, 0x00020000
    s_cmp_ge_u32 s3, 2
    s_cbranch_scc1 C_W2
    v_lshrrev_b32 v2, 1, v1
    v_lshlrev_b32 v2, 11, v2
    v_and_b32 v5, 1, v1
    v_lshl_add_u32 v2, v5, 7, v2
    s_lshl_b32 s7, s5, 1
    s_add_u32 s7, s7, s3
    s_lshl_b32 s7, s7, 16
    s_lshl_b32 s8, s4, 8
    s_add_u32 s7, s7, s8
    s_waitcnt lgkmcnt(0)
    buffer_load_dword v90, v2, s[36:39], s7 offen
    s_branch C_S1
C_W2:
    s_lshl_b32 s7, s5, 3
    s_add_u32 s7, s7, s3
    s_cmp_lg_u32 s7, 4
    s_cbranch_scc1 C_W3
    s_getpc_b64 s[24:25]
PC_1:
    s_sub_u32 s24, s24, PC_1-standalone__weight_only_int_quip__sampling_kernel
    s_subb_u32 s25, s25, 0
    v_lshlrev_b32 v5, 7, v1
    global_load_dword v90, v5, s[24:25]
    v_add_u32 v5, 0x2000, v5
    v_cmp_gt_u32 vcc, CODE_END-standalone__weight_only_int_quip__sampling_kernel, v5
    s_and_saveexec_b64 s[56:57], vcc
    global_load_dword v91, v5, s[24:25]
    s_mov_b64 exec, -1
C_W3:
    s_cmp_lg_u32 s3, 2
    s_cbranch_scc1 C_S1
    v_lshlrev_b32 v5, 7, v1
    s_lshl_b32 s8, s5, 13
    s_waitcnt lgkmcnt(0)
    buffer_load_dword v90, v5, s[40:43], s8 offen
    s_branch C_S1
ROLE_B:
    s_mul_i32 s6, s4, 14
    s_add_u32 s6, s6, s5
    v_lshrrev_b32 v100, 3, v1
    v_and_b32 v101, 7, v1
    v_mul_u32_u24 v5, 114688, v100
    v_lshl_add_u32 v5, v101, 4, v5
    v_lshrrev_b32 v2, 5, v1
    v_mul_u32_u24 v2, 7168, v2
    v_lshl_add_u32 v2, v101, 3, v2
    s_mov_b32 s38, 0x38000
    s_mov_b32 s39, 0x00020000
    s_mov_b32 s42, 0x38000
    s_mov_b32 s43, 0x00020000
    s_mul_i32 s8, s3, 1835008
    s_lshl_b32 s9, s6, 7
    s_add_u32 s8, s8, s9
    s_mul_i32 s9, s3, 28672
    s_lshl_b32 s10, s6, 6
    s_add_u32 s9, s9, s10
    s_add_u32 s10, s9, 14336
    s_and_b32 s12, s6, 7
    s_waitcnt lgkmcnt(0)
    buffer_load_dwordx2 v[80:81], v2, s[36:39], s9 offen
    buffer_load_dwordx2 v[84:85], v2, s[40:43], s9 offen
    buffer_load_dwordx2 v[82:83], v2, s[36:39], s10 offen
    buffer_load_dwordx2 v[86:87], v2, s[40:43], s10 offen
    s_cmp_eq_u32 s12, 3
    s_cbranch_scc1 B_SLOWTILE
B_OWN:
    s_load_dword s34, s[48:49], 0
    s_load_dwordx2 s[52:53], s[0:1], 48
    s_load_dwordx2 s[44:45], s[0:1], 40
    s_lshl_b32 s7, s6, 11
    s_add_u32 s7, s7, 262144
    s_cmp_lg_u32 s3, 0
    s_cbranch_scc1 B_NOPOIS
    v_mov_b32 v112, -1
    v_mov_b32 v113, -1
    v_mov_b32 v114, -1
    v_mov_b32 v115, -1
    s_add_u32 s12, s7, 229376
    buffer_store_dwordx4 v[112:115], v98, s[48:51], s7 offen offset:0 sc1
    buffer_store_dwordx4 v[112:115], v98, s[48:51], s12 offen offset:0 sc1
    buffer_store_dwordx4 v[112:115], v98, s[48:51], s7 offen offset:1024 sc1
    buffer_store_dwordx4 v[112:115], v98, s[48:51], s12 offen offset:1024 sc1
B_NOPOIS:
    s_lshl_b32 s21, s2, 3
    s_add_u32 s21, s21, s3
    s_lshl_b32 s21, s21, 5
    s_getpc_b64 s[22:23]
    s_add_u32 s22, s22, tab_vh@rel32@lo+4
    s_addc_u32 s23, s23, tab_vh@rel32@hi+12
    s_load_dwordx4 s[24:27], s[22:23], s21
    s_add_u32 s21, s21, 16
    s_load_dwordx4 s[96:99], s[22:23], s21
    s_lshr_b32 s11, s3, 2
    s_and_b32 s10, s3, 1
    s_bfe_u32 s16, s3, 0x10001
    s_lshl_b32 s12, s11, 1
    s_add_u32 s12, s12, s10
    s_lshl_b32 s56, s12, 11
    s_add_u32 s56, s56, 65536
    v_add_u32 v107, s56, v98
    s_lshl_b32 s12, s12, 5
    s_lshl_b32 s13, s16, 4
    s_add_u32 s12, s12, s13
    s_mul_i32 s15, s12, 16
    s_add_u32 s15, s15, 4096
    v_mul_u32_u24 v102, 16, v3
    s_mov_b32 s54, 0x70000
    s_mov_b32 s55, 0x00020000
    s_mov_b32 s46, 0x1880000
    s_mov_b32 s47, 0x00020000
    s_lshl_b32 s12, s12, 10
    s_add_u32 s12, s12, 65536
    s_and_b32 s13, s5, 3
    s_sub_u32 s14, s3, s13
    s_and_b32 s14, s14, 3
    s_lshl_b32 s56, s11, 2
    s_add_u32 s14, s14, s56
    s_lshl_b32 s14, s14, 13
    v_lshrrev_b32 v104, 2, v100
    v_lshlrev_b32 v104, 11, v104
    v_and_b32 v105, 3, v100
    v_lshl_add_u32 v104, v105, 8, v104
    v_lshl_add_u32 v104, v101, 5, v104
    v_add_u32 v104, s14, v104
    s_lshl_b32 s14, s16, 15
    v_add_u32 v105, s14, v98
    s_lshl_b32 s13, s13, 12
    s_mov_b32 s57, 0xffff0000
    s_and_b32 s56, s5, 7
    s_lshl_b32 s56, s56, 7
    v_lshl_add_u32 v106, v3, 10, s56
    v_lshrrev_b32 v110, 1, v4
    v_lshlrev_b32 v110, 10, v110
    v_and_b32 v111, 1, v4
    v_lshl_add_u32 v110, v111, 9, v110
    v_lshl_add_u32 v110, v3, 4, v110
    s_mul_i32 s56, s11, 229376
    s_add_u32 s7, s7, s56
    s_lshl_b32 s56, s10, 8
    s_add_u32 s7, s7, s56
    s_mov_b32 s14, 0
    s_mov_b32 s58, 0
    s_waitcnt lgkmcnt(0)
    buffer_load_dwordx4 v[16:19], v5, s[28:31], s8 offen nt
    s_add_u32 s8, s8, 14336
    buffer_load_dwordx4 v[20:23], v5, s[28:31], s8 offen nt
    s_add_u32 s8, s8, 14336
    buffer_load_dwordx4 v[24:27], v5, s[28:31], s8 offen nt
    s_add_u32 s8, s8, 14336
    buffer_load_dwordx4 v[28:31], v5, s[28:31], s8 offen nt
    s_add_u32 s8, s8, 14336
    s_waitcnt vmcnt(4)
    v_lshlrev_b32 v88, 16, v80
    v_and_b32 v89, s57, v80
    v_lshlrev_b32 v92, 16, v84
    v_and_b32 v93, s57, v84
    v_lshlrev_b32 v90, 16, v81
    v_and_b32 v91, s57, v81
    v_lshlrev_b32 v94, 16, v85
    v_and_b32 v95, s57, v85
    v_pk_mul_f32 v[92:93], v[92:93], v[88:89]
    v_pk_mul_f32 v[94:95], v[94:95], v[90:91]
    s_waitcnt vmcnt(3)
    buffer_load_dwordx4 v[32:35], v5, s[28:31], s8 offen nt
    s_add_u32 s8, s8, 14336
    v_cvt_f32_i32 v16, v16
    v_cvt_f32_i32 v17, v17
    v_cvt_f32_i32 v18, v18
    v_cvt_f32_i32 v19, v19
    v_pk_fma_f32 v[16:17], v[16:17], v[88:89], v[92:93] neg_lo:[0,0,1] neg_hi:[0,0,1]
    v_pk_fma_f32 v[18:19], v[18:19], v[90:91], v[94:95] neg_lo:[0,0,1] neg_hi:[0,0,1]
    s_waitcnt vmcnt(3)
    buffer_load_dwordx4 v[36:39], v5, s[28:31], s8 offen nt
    s_add_u32 s8, s8, 14336
    v_cvt_f32_i32 v20, v20
    v_cvt_f32_i32 v21, v21
    v_cvt_f32_i32 v22, v22
    v_cvt_f32_i32 v23, v23
    v_pk_fma_f32 v[20:21], v[20:21], v[88:89], v[92:93] neg_lo:[0,0,1] neg_hi:[0,0,1]
    v_pk_fma_f32 v[22:23], v[22:23], v[90:91], v[94:95] neg_lo:[0,0,1] neg_hi:[0,0,1]
    v_cvt_pk_bf16_f32 v112, v16, v20
    v_cvt_pk_bf16_f32 v116, v17, v21
    v_cvt_pk_bf16_f32 v120, v18, v22
    v_cvt_pk_bf16_f32 v124, v19, v23
    s_waitcnt vmcnt(3)
    buffer_load_dwordx4 v[40:43], v5, s[28:31], s8 offen nt
    s_add_u32 s8, s8, 14336
    v_cvt_f32_i32 v24, v24
    v_cvt_f32_i32 v25, v25
    v_cvt_f32_i32 v26, v26
    v_cvt_f32_i32 v27, v27
    v_pk_fma_f32 v[24:25], v[24:25], v[88:89], v[92:93] neg_lo:[0,0,1] neg_hi:[0,0,1]
    v_pk_fma_f32 v[26:27], v[26:27], v[90:91], v[94:95] neg_lo:[0,0,1] neg_hi:[0,0,1]
    s_waitcnt vmcnt(3)
    buffer_load_dwordx4 v[44:47], v5, s[28:31], s8 offen nt
    s_add_u32 s8, s8, 817152
    v_cvt_f32_i32 v28, v28
    v_cvt_f32_i32 v29, v29
    v_cvt_f32_i32 v30, v30
    v_cvt_f32_i32 v31, v31
    v_pk_fma_f32 v[28:29], v[28:29], v[88:89], v[92:93] neg_lo:[0,0,1] neg_hi:[0,0,1]
    v_pk_fma_f32 v[30:31], v[30:31], v[90:91], v[94:95] neg_lo:[0,0,1] neg_hi:[0,0,1]
    v_cvt_pk_bf16_f32 v113, v24, v28
    v_cvt_pk_bf16_f32 v117, v25, v29
    v_cvt_pk_bf16_f32 v121, v26, v30
    v_cvt_pk_bf16_f32 v125, v27, v31
    s_waitcnt vmcnt(3)
    s_waitcnt lgkmcnt(0)
    s_add_u32 s34, s34, 1
    v_mov_b32 v7, s34
    s_cmp_lg_u32 s3, 0
    s_cbranch_scc1 B_NOFLAG
    s_mul_i32 s56, s6, 16
    s_add_u32 s56, s56, 8192
    s_mov_b64 exec, 0x1
    buffer_store_dword v7, v6, s[48:51], s56 offen sc1
    s_mov_b64 exec, -1
B_NOFLAG:
    buffer_load_dwordx4 v[48:51], v5, s[28:31], s8 offen nt
    s_add_u32 s8, s8, 14336
    v_cvt_f32_i32 v32, v32
    v_cvt_f32_i32 v33, v33
    v_cvt_f32_i32 v34, v34
    v_cvt_f32_i32 v35, v35
    v_pk_fma_f32 v[32:33], v[32:33], v[88:89], v[92:93] neg_lo:[0,0,1] neg_hi:[0,0,1]
    v_pk_fma_f32 v[34:35], v[34:35], v[90:91], v[94:95] neg_lo:[0,0,1] neg_hi:[0,0,1]
    s_waitcnt vmcnt(3)
    buffer_load_dwordx4 v[52:55], v5, s[28:31], s8 offen nt
    s_add_u32 s8, s8, 14336
    s_mov_b64 exec, 0xffff
    buffer_load_dword v103, v102, s[48:51], s15 offen sc1
    s_mov_b64 exec, -1
    v_cvt_f32_i32 v36, v36
    v_cvt_f32_i32 v37, v37
    v_cvt_f32_i32 v38, v38
    v_cvt_f32_i32 v39, v39
    v_pk_fma_f32 v[36:37], v[36:37], v[88:89], v[92:93] neg_lo:[0,0,1] neg_hi:[0,0,1]
    v_pk_fma_f32 v[38:39], v[38:39], v[90:91], v[94:95] neg_lo:[0,0,1] neg_hi:[0,0,1]
    v_cvt_pk_bf16_f32 v114, v32, v36
    v_cvt_pk_bf16_f32 v118, v33, v37
    v_cvt_pk_bf16_f32 v122, v34, v38
    v_cvt_pk_bf16_f32 v126, v35, v39
    s_waitcnt vmcnt(4)
    buffer_load_dwordx4 v[56:59], v5, s[28:31], s8 offen nt
    s_add_u32 s8, s8, 14336
    v_cvt_f32_i32 v40, v40
    v_cvt_f32_i32 v41, v41
    v_cvt_f32_i32 v42, v42
    v_cvt_f32_i32 v43, v43
    v_pk_fma_f32 v[40:41], v[40:41], v[88:89], v[92:93] neg_lo:[0,0,1] neg_hi:[0,0,1]
    v_pk_fma_f32 v[42:43], v[42:43], v[90:91], v[94:95] neg_lo:[0,0,1] neg_hi:[0,0,1]
    s_waitcnt vmcnt(4)
    buffer_load_dwordx4 v[60:63], v5, s[28:31], s8 offen nt
    s_add_u32 s8, s8, 14336
    v_cvt_f32_i32 v44, v44
    v_cvt_f32_i32 v45, v45
    v_cvt_f32_i32 v46, v46
    v_cvt_f32_i32 v47, v47
    v_pk_fma_f32 v[44:45], v[44:45], v[88:89], v[92:93] neg_lo:[0,0,1] neg_hi:[0,0,1]
    v_pk_fma_f32 v[46:47], v[46:47], v[90:91], v[94:95] neg_lo:[0,0,1] neg_hi:[0,0,1]
    v_cvt_pk_bf16_f32 v115, v40, v44
    v_cvt_pk_bf16_f32 v119, v41, v45
    v_cvt_pk_bf16_f32 v123, v42, v46
    v_cvt_pk_bf16_f32 v127, v43, v47
    ds_write_b128 v104, v[112:115] offset:0
    ds_write_b128 v104, v[116:119] offset:1024
    ds_write_b128 v104, v[120:123] offset:16
    ds_write_b128 v104, v[124:127] offset:1040
    v_lshlrev_b32 v88, 16, v82
    v_and_b32 v89, s57, v82
    v_lshlrev_b32 v92, 16, v86
    v_and_b32 v93, s57, v86
    v_lshlrev_b32 v90, 16, v83
    v_and_b32 v91, s57, v83
    v_lshlrev_b32 v94, 16, v87
    v_and_b32 v95, s57, v87
    v_pk_mul_f32 v[92:93], v[92:93], v[88:89]
    v_pk_mul_f32 v[94:95], v[94:95], v[90:91]
    s_waitcnt vmcnt(4)
    buffer_load_dwordx4 v[64:67], v5, s[28:31], s8 offen nt
    s_add_u32 s8, s8, 14336
    v_cvt_f32_i32 v48, v48
    v_cvt_f32_i32 v49, v49
    v_cvt_f32_i32 v50, v50
    v_cvt_f32_i32 v51, v51
    v_pk_fma_f32 v[48:49], v[48:49], v[88:89], v[92:93] neg_lo:[0,0,1] neg_hi:[0,0,1]
    v_pk_fma_f32 v[50:51], v[50:51], v[90:91], v[94:95] neg_lo:[0,0,1] neg_hi:[0,0,1]
    s_waitcnt vmcnt(4)
    buffer_load_dwordx4 v[68:71], v5, s[28:31], s8 offen nt
    s_add_u32 s8, s8, 14336
    v_cvt_f32_i32 v52, v52
    v_cvt_f32_i32 v53, v53
    v_cvt_f32_i32 v54, v54
    v_cvt_f32_i32 v55, v55
    v_pk_fma_f32 v[52:53], v[52:53], v[88:89], v[92:93] neg_lo:[0,0,1] neg_hi:[0,0,1]
    v_pk_fma_f32 v[54:55], v[54:55], v[90:91], v[94:95] neg_lo:[0,0,1] neg_hi:[0,0,1]
    v_cvt_pk_bf16_f32 v128, v48, v52
    v_cvt_pk_bf16_f32 v132, v49, v53
    v_cvt_pk_bf16_f32 v136, v50, v54
    v_cvt_pk_bf16_f32 v140, v51, v55
    s_waitcnt vmcnt(4)
    s_mov_b64 exec, 0xffff
    v_cmp_ne_u32 vcc, s34, v103
    s_cbranch_vccz B_PF1_OK
    s_mov_b32 s14, 0
B_PF1:
    buffer_load_dword v103, v102, s[48:51], s15 offen sc1
    s_waitcnt vmcnt(0)
    v_cmp_ne_u32 vcc, s34, v103
    s_cbranch_vccz B_PF1_OK
    s_sleep 4
    s_add_u32 s14, s14, 1
    s_cmp_lt_u32 s14, 200000
    s_cbranch_scc1 B_PF1
B_PF1_OK:
    s_mov_b64 exec, -1
    s_waitcnt vmcnt(3)
    buffer_load_dwordx4 v[72:75], v5, s[28:31], s8 offen nt
    s_add_u32 s8, s8, 14336
    v_cvt_f32_i32 v56, v56
    v_cvt_f32_i32 v57, v57
    v_cvt_f32_i32 v58, v58
    v_cvt_f32_i32 v59, v59
    v_pk_fma_f32 v[56:57], v[56:57], v[88:89], v[92:93] neg_lo:[0,0,1] neg_hi:[0,0,1]
    v_pk_fma_f32 v[58:59], v[58:59], v[90:91], v[94:95] neg_lo:[0,0,1] neg_hi:[0,0,1]
    s_waitcnt vmcnt(3)
    buffer_load_dwordx4 v[76:79], v5, s[28:31], s8 offen nt
    v_cvt_f32_i32 v60, v60
    v_cvt_f32_i32 v61, v61
    v_cvt_f32_i32 v62, v62
    v_cvt_f32_i32 v63, v63
    v_pk_fma_f32 v[60:61], v[60:61], v[88:89], v[92:93] neg_lo:[0,0,1] neg_hi:[0,0,1]
    v_pk_fma_f32 v[62:63], v[62:63], v[90:91], v[94:95] neg_lo:[0,0,1] neg_hi:[0,0,1]
    v_cvt_pk_bf16_f32 v129, v56, v60
    v_cvt_pk_bf16_f32 v133, v57, v61
    v_cvt_pk_bf16_f32 v137, v58, v62
    v_cvt_pk_bf16_f32 v141, v59, v63
    s_waitcnt vmcnt(3)
    s_mov_b64 exec, 0xffff
    buffer_load_dword v109, v106, s[48:51], s12 offen sc1
    s_mov_b64 exec, -1
    v_cvt_f32_i32 v64, v64
    v_cvt_f32_i32 v65, v65
    v_cvt_f32_i32 v66, v66
    v_cvt_f32_i32 v67, v67
    v_pk_fma_f32 v[64:65], v[64:65], v[88:89], v[92:93] neg_lo:[0,0,1] neg_hi:[0,0,1]
    v_pk_fma_f32 v[66:67], v[66:67], v[90:91], v[94:95] neg_lo:[0,0,1] neg_hi:[0,0,1]
    s_waitcnt vmcnt(3)
    v_cvt_f32_i32 v68, v68
    v_cvt_f32_i32 v69, v69
    v_cvt_f32_i32 v70, v70
    v_cvt_f32_i32 v71, v71
    v_pk_fma_f32 v[68:69], v[68:69], v[88:89], v[92:93] neg_lo:[0,0,1] neg_hi:[0,0,1]
    v_pk_fma_f32 v[70:71], v[70:71], v[90:91], v[94:95] neg_lo:[0,0,1] neg_hi:[0,0,1]
    v_cvt_pk_bf16_f32 v130, v64, v68
    v_cvt_pk_bf16_f32 v134, v65, v69
    v_cvt_pk_bf16_f32 v138, v66, v70
    v_cvt_pk_bf16_f32 v142, v67, v71
    s_waitcnt vmcnt(2)
    v_cvt_f32_i32 v72, v72
    v_cvt_f32_i32 v73, v73
    v_cvt_f32_i32 v74, v74
    v_cvt_f32_i32 v75, v75
    v_pk_fma_f32 v[72:73], v[72:73], v[88:89], v[92:93] neg_lo:[0,0,1] neg_hi:[0,0,1]
    v_pk_fma_f32 v[74:75], v[74:75], v[90:91], v[94:95] neg_lo:[0,0,1] neg_hi:[0,0,1]
    s_waitcnt vmcnt(1)
    v_cvt_f32_i32 v76, v76
    v_cvt_f32_i32 v77, v77
    v_cvt_f32_i32 v78, v78
    v_cvt_f32_i32 v79, v79
    v_pk_fma_f32 v[76:77], v[76:77], v[88:89], v[92:93] neg_lo:[0,0,1] neg_hi:[0,0,1]
    v_pk_fma_f32 v[78:79], v[78:79], v[90:91], v[94:95] neg_lo:[0,0,1] neg_hi:[0,0,1]
    v_cvt_pk_bf16_f32 v131, v72, v76
    v_cvt_pk_bf16_f32 v135, v73, v77
    v_cvt_pk_bf16_f32 v139, v74, v78
    v_cvt_pk_bf16_f32 v143, v75, v79
    ds_write_b128 v104, v[128:131] offset:4096
    ds_write_b128 v104, v[132:135] offset:5120
    ds_write_b128 v104, v[136:139] offset:4112
    ds_write_b128 v104, v[140:143] offset:5136
    v_lshrrev_b32 v103, 2, v107
    v_add_u32 v103, 57344, v103
    ds_write_b32 v103, v6
    s_cmp_eq_u32 s11, 0
    s_cbranch_scc1 B_NOA
    s_waitcnt lgkmcnt(0)
    s_barrier
B_NOA:
    s_mov_b64 exec, 0xffff
    s_setprio 3
B_SENT:
    s_waitcnt vmcnt(0)
    v_cmp_eq_u32 vcc, -1, v109
    s_cbranch_vccz B_XR
    s_sleep 2
    buffer_load_dword v109, v106, s[48:51], s12 offen sc1
    s_add_u32 s14, s14, 1
    s_cmp_lt_u32 s14, 200000
    s_cbranch_scc1 B_SENT
B_XR:
    s_mov_b64 exec, -1
    s_cmp_eq_u32 s11, 0
    s_cbranch_scc1 B_KEEPPRIO
    s_setprio 0
B_KEEPPRIO:
    s_add_u32 s56, s12, s13
    buffer_load_dwordx4 v[144:147], v98, s[48:51], s56 offen offset:0 sc1
    buffer_load_dwordx4 v[148:151], v98, s[48:51], s56 offen offset:1024 sc1
    buffer_load_dwordx4 v[152:155], v98, s[48:51], s56 offen offset:2048 sc1
    buffer_load_dwordx4 v[156:159], v98, s[48:51], s56 offen offset:3072 sc1
    s_add_u32 s13, s13, 4096
    s_and_b32 s13, s13, 0x3fff
    s_add_u32 s56, s12, s13
    buffer_load_dwordx4 v[160:163], v98, s[48:51], s56 offen offset:0 sc1
    buffer_load_dwordx4 v[164:167], v98, s[48:51], s56 offen offset:1024 sc1
    buffer_load_dwordx4 v[168:171], v98, s[48:51], s56 offen offset:2048 sc1
    buffer_load_dwordx4 v[172:175], v98, s[48:51], s56 offen offset:3072 sc1
    s_add_u32 s13, s13, 4096
    s_and_b32 s13, s13, 0x3fff
    s_add_u32 s56, s12, s13
    s_or_b32 s59, s58, s11
    s_cmp_lg_u32 s59, 0
    s_cbranch_scc1 B_NOA2
    s_waitcnt lgkmcnt(0)
    s_barrier
B_NOA2:
    ds_read_b128 v[16:19], v105 offset:0
    ds_read_b128 v[20:23], v105 offset:1024
    ds_read_b128 v[24:27], v105 offset:2048
    ds_read_b128 v[28:31], v105 offset:3072
    ds_read_b128 v[32:35], v105 offset:4096
    ds_read_b128 v[36:39], v105 offset:5120
    ds_read_b128 v[40:43], v105 offset:6144
    ds_read_b128 v[44:47], v105 offset:7168
    ds_read_b128 v[48:51], v105 offset:8192
    ds_read_b128 v[52:55], v105 offset:9216
    ds_read_b128 v[56:59], v105 offset:10240
    ds_read_b128 v[60:63], v105 offset:11264
    ds_read_b128 v[64:67], v105 offset:12288
    ds_read_b128 v[68:71], v105 offset:13312
    buffer_load_dwordx4 v[176:179], v98, s[48:51], s56 offen offset:0 sc1
    buffer_load_dwordx4 v[180:183], v98, s[48:51], s56 offen offset:1024 sc1
    buffer_load_dwordx4 v[184:187], v98, s[48:51], s56 offen offset:2048 sc1
    buffer_load_dwordx4 v[188:191], v98, s[48:51], s56 offen offset:3072 sc1
    s_add_u32 s13, s13, 4096
    s_and_b32 s13, s13, 0x3fff
    s_add_u32 s56, s12, s13
    buffer_load_dwordx4 v[192:195], v98, s[48:51], s56 offen offset:0 sc1
    buffer_load_dwordx4 v[196:199], v98, s[48:51], s56 offen offset:1024 sc1
    buffer_load_dwordx4 v[200:203], v98, s[48:51], s56 offen offset:2048 sc1
    buffer_load_dwordx4 v[204:207], v98, s[48:51], s56 offen offset:3072 sc1
    s_add_u32 s13, s13, 4096
    s_and_b32 s13, s13, 0x3fff
    v_mov_b32 v108, 0
    s_waitcnt vmcnt(15) lgkmcnt(12)
    v_mfma_f32_16x16x32_bf16 v[8:11], v[16:19], v[144:147], 0
    ds_read_b128 v[72:75], v105 offset:14336
    v_mfma_f32_16x16x32_bf16 v[12:15], v[20:23], v[144:147], 0
    ds_read_b128 v[76:79], v105 offset:15360
    v_max3_u32 v108, v108, v144, v146
    s_waitcnt vmcnt(14) lgkmcnt(12)
    v_mfma_f32_16x16x32_bf16 v[8:11], v[24:27], v[148:151], v[8:11]
    ds_read_b128 v[112:115], v105 offset:16384
    v_mfma_f32_16x16x32_bf16 v[12:15], v[28:31], v[148:151], v[12:15]
    ds_read_b128 v[116:119], v105 offset:17408
    v_max3_u32 v108, v108, v148, v150
    s_waitcnt vmcnt(13) lgkmcnt(12)
    v_mfma_f32_16x16x32_bf16 v[8:11], v[32:35], v[152:155], v[8:11]
    ds_read_b128 v[120:123], v105 offset:18432
    v_mfma_f32_16x16x32_bf16 v[12:15], v[36:39], v[152:155], v[12:15]
    ds_read_b128 v[124:127], v105 offset:19456
    v_max3_u32 v108, v108, v152, v154
    s_waitcnt vmcnt(12) lgkmcnt(12)
    v_mfma_f32_16x16x32_bf16 v[8:11], v[40:43], v[156:159], v[8:11]
    ds_read_b128 v[128:131], v105 offset:20480
    v_mfma_f32_16x16x32_bf16 v[12:15], v[44:47], v[156:159], v[12:15]
    ds_read_b128 v[132:135], v105 offset:21504
    v_max3_u32 v108, v108, v156, v158
    s_waitcnt vmcnt(11) lgkmcnt(12)
    v_mfma_f32_16x16x32_bf16 v[8:11], v[48:51], v[160:163], v[8:11]
    ds_read_b128 v[136:139], v105 offset:22528
    v_mfma_f32_16x16x32_bf16 v[12:15], v[52:55], v[160:163], v[12:15]
    ds_read_b128 v[140:143], v105 offset:23552
    v_max3_u32 v108, v108, v160, v162
    s_waitcnt vmcnt(10) lgkmcnt(12)
    v_mfma_f32_16x16x32_bf16 v[8:11], v[56:59], v[164:167], v[8:11]
    ds_read_b128 v[208:211], v105 offset:24576
    v_mfma_f32_16x16x32_bf16 v[12:15], v[60:63], v[164:167], v[12:15]
    ds_read_b128 v[212:215], v105 offset:25600
    v_max3_u32 v108, v108, v164, v166
    s_waitcnt vmcnt(9) lgkmcnt(12)
    v_mfma_f32_16x16x32_bf16 v[8:11], v[64:67], v[168:171], v[8:11]
    ds_read_b128 v[216:219], v105 offset:26624
    v_mfma_f32_16x16x32_bf16 v[12:15], v[68:71], v[168:171], v[12:15]
    ds_read_b128 v[220:223], v105 offset:27648
    v_max3_u32 v108, v108, v168, v170
    s_waitcnt vmcnt(8) lgkmcnt(12)
    v_mfma_f32_16x16x32_bf16 v[8:11], v[72:75], v[172:175], v[8:11]
    ds_read_b128 v[224:227], v105 offset:28672
    v_mfma_f32_16x16x32_bf16 v[12:15], v[76:79], v[172:175], v[12:15]
    ds_read_b128 v[228:231], v105 offset:29696
    v_max3_u32 v108, v108, v172, v174
    s_waitcnt vmcnt(7) lgkmcnt(12)
    v_mfma_f32_16x16x32_bf16 v[8:11], v[112:115], v[176:179], v[8:11]
    ds_read_b128 v[232:235], v105 offset:30720
    v_mfma_f32_16x16x32_bf16 v[12:15], v[116:119], v[176:179], v[12:15]
    ds_read_b128 v[236:239], v105 offset:31744
    v_max3_u32 v108, v108, v176, v178
    s_waitcnt vmcnt(6) lgkmcnt(12)
    v_mfma_f32_16x16x32_bf16 v[8:11], v[120:123], v[180:183], v[8:11]
    v_mfma_f32_16x16x32_bf16 v[12:15], v[124:127], v[180:183], v[12:15]
    v_max3_u32 v108, v108, v180, v182
    s_waitcnt vmcnt(5) lgkmcnt(10)
    v_mfma_f32_16x16x32_bf16 v[8:11], v[128:131], v[184:187], v[8:11]
    v_mfma_f32_16x16x32_bf16 v[12:15], v[132:135], v[184:187], v[12:15]
    v_max3_u32 v108, v108, v184, v186
    s_waitcnt vmcnt(4) lgkmcnt(8)
    v_mfma_f32_16x16x32_bf16 v[8:11], v[136:139], v[188:191], v[8:11]
    v_mfma_f32_16x16x32_bf16 v[12:15], v[140:143], v[188:191], v[12:15]
    v_max3_u32 v108, v108, v188, v190
    s_waitcnt vmcnt(3) lgkmcnt(6)
    v_mfma_f32_16x16x32_bf16 v[8:11], v[208:211], v[192:195], v[8:11]
    v_mfma_f32_16x16x32_bf16 v[12:15], v[212:215], v[192:195], v[12:15]
    v_max3_u32 v108, v108, v192, v194
    s_waitcnt vmcnt(2) lgkmcnt(4)
    v_mfma_f32_16x16x32_bf16 v[8:11], v[216:219], v[196:199], v[8:11]
    v_mfma_f32_16x16x32_bf16 v[12:15], v[220:223], v[196:199], v[12:15]
    v_max3_u32 v108, v108, v196, v198
    s_waitcnt vmcnt(1) lgkmcnt(2)
    v_mfma_f32_16x16x32_bf16 v[8:11], v[224:227], v[200:203], v[8:11]
    v_mfma_f32_16x16x32_bf16 v[12:15], v[228:231], v[200:203], v[12:15]
    v_max3_u32 v108, v108, v200, v202
    s_waitcnt vmcnt(0) lgkmcnt(0)
    v_mfma_f32_16x16x32_bf16 v[8:11], v[232:235], v[204:207], v[8:11]
    v_mfma_f32_16x16x32_bf16 v[12:15], v[236:239], v[204:207], v[12:15]
    v_max3_u32 v108, v108, v204, v206
    v_cmp_eq_u32 vcc, -1, v108
    s_add_u32 s58, s58, 1
    s_cbranch_vccz B_XOK
    v_mov_b32 v109, -1
    s_cmp_lt_u32 s58, 200000
    s_cbranch_scc1 B_NOA
B_XOK:
    s_cmp_lg_u32 s16, 0
    s_cbranch_scc1 B_HOUT
    v_mov_b32 v109, 1
    s_nop 1
    ds_write_b128 v107, v[8:11]
    ds_write_b128 v107, v[12:15] offset:1024
    ds_write_b32 v103, v109
    s_setprio 0
    s_branch B_RED
B_HOUT:
    s_mov_b32 s14, 0
B_PAIR:
    ds_read_b32 v109, v103
    ds_read_b128 v[16:19], v107
    ds_read_b128 v[20:23], v107 offset:1024
    s_waitcnt lgkmcnt(0)
    v_cmp_ne_u32 vcc, 1, v109
    s_cbranch_vccz B_PAIR_OK
    s_add_u32 s14, s14, 1
    s_cmp_lt_u32 s14, 12800000
    s_cbranch_scc1 B_PAIR
B_PAIR_OK:
    v_pk_add_f32 v[8:9], v[8:9], v[16:17]
    v_pk_add_f32 v[10:11], v[10:11], v[18:19]
    v_pk_add_f32 v[12:13], v[12:13], v[20:21]
    v_pk_add_f32 v[14:15], v[14:15], v[22:23]
    v_cvt_pk_bf16_f32 v112, v8, v12
    v_cvt_pk_bf16_f32 v113, v9, v13
    v_cvt_pk_bf16_f32 v114, v10, v14
    v_cvt_pk_bf16_f32 v115, v11, v15
    v_min_u32 v112, -2, v112
    v_min_u32 v113, -2, v113
    v_min_u32 v114, -2, v114
    v_min_u32 v115, -2, v115
    buffer_store_dwordx4 v[112:115], v110, s[48:51], s7 offen sc1
    s_setprio 0
B_RED:
    s_lshr_b32 s8, s6, 2
    s_and_b32 s9, s6, 3
    s_mul_i32 s12, s8, 163840
    s_lshl_b32 s13, s3, 12
    s_add_u32 s12, s12, s13
    s_lshl_b32 s13, s9, 7
    s_add_u32 s12, s12, s13
    s_add_u32 s12, s12, 1048576
    s_add_u32 s56, s12, 32768
    s_add_u32 s57, s12, 65536
    s_add_u32 s58, s12, 98304
    s_add_u32 s59, s12, 131072
    v_and_b32 v106, 3, v100
    v_lshlrev_b32 v106, 10, v106
    v_lshrrev_b32 v107, 5, v1
    v_lshl_add_u32 v106, v107, 9, v106
    v_lshl_add_u32 v106, v101, 4, v106
    v_mul_u32_u24 v107, 7168, v101
    v_lshl_add_u32 v107, v100, 3, v107
    v_lshlrev_b32 v109, 15, v1
    s_lshl_b32 s13, s11, 2
    s_add_u32 s13, s13, s9
    s_mul_i32 s13, s13, 57344
    s_lshl_b32 s15, s8, 8
    s_add_u32 s13, s13, s15
    s_and_b32 s15, s3, 3
    s_lshl_b32 s15, s15, 6
    s_add_u32 s13, s13, s15
    s_and_b32 s35, s34, 0xff
    v_lshrrev_b32 v102, 1, v1
    v_mul_u32_u24 v102, 7168, v102
    v_and_b32 v103, 1, v1
    v_lshl_add_u32 v102, v103, 7, v102
    s_barrier
    s_cmp_eq_u32 s24, -1
    s_cbranch_scc1 B_NOVH
    buffer_load_dword v111, v102, s[44:47], s24 offen
    s_cmp_eq_u32 s25, -1
    s_cbranch_scc1 B_NOVH
    s_waitcnt vmcnt(0)
    buffer_load_dword v111, v102, s[44:47], s25 offen
    s_cmp_eq_u32 s26, -1
    s_cbranch_scc1 B_NOVH
    s_waitcnt vmcnt(0)
    buffer_load_dword v111, v102, s[44:47], s26 offen
B_NOVH:
    s_or_b32 s21, s2, s3
    s_cmp_lg_u32 s21, 0
    s_cbranch_scc1 B_RED2
    s_mov_b32 s21, 12288
    s_mov_b64 exec, 0xfff
    s_mov_b32 s14, 0
B_KEEP:
    buffer_load_dword v104, v98, s[48:51], s21 offen sc1
    s_waitcnt vmcnt(0)
    v_cmp_ne_u32 vcc, s34, v104
    s_cbranch_vccz B_KEEP_OK
    s_sleep 4
    s_add_u32 s14, s14, 1
    s_cmp_lt_u32 s14, 200000
    s_cbranch_scc1 B_KEEP
B_KEEP_OK:
    s_mov_b64 exec, -1
B_RED2:
    s_cmp_lg_u32 s3, 0
    s_cbranch_scc1 B_POLLB
    s_mov_b32 s14, 0
    s_mov_b64 exec, 0x1f
B_PS0:
    buffer_load_dwordx4 v[40:43], v109, s[48:51], s12 offen sc1
    s_waitcnt vmcnt(0)
    v_xor_b32 v40, s35, v40
    v_xor_b32 v41, s35, v41
    v_xor_b32 v42, s35, v42
    v_xor_b32 v43, s35, v43
    v_or3_b32 v40, v40, v41, v42
    v_or_b32 v40, v40, v43
    v_and_b32 v40, 0xff, v40
    v_cmp_ne_u32 vcc, 0, v40
    s_cbranch_vccz B_PS0_OK
    s_sleep 1
    s_add_u32 s14, s14, 1
    s_cmp_lt_u32 s14, 200000
    s_cbranch_scc1 B_PS0
B_PS0_OK:
    s_mov_b64 exec, -1
B_POLLB:
    s_barrier
    s_mov_b32 s14, 0
B_POLL3:
    buffer_load_dwordx4 v[16:19], v106, s[48:51], s12 offen sc1
    buffer_load_dwordx4 v[20:23], v106, s[48:51], s56 offen sc1
    buffer_load_dwordx4 v[24:27], v106, s[48:51], s57 offen sc1
    buffer_load_dwordx4 v[28:31], v106, s[48:51], s58 offen sc1
    buffer_load_dwordx4 v[32:35], v106, s[48:51], s59 offen sc1
    s_waitcnt vmcnt(4)
    v_xor_b32 v16, s35, v16
    v_xor_b32 v17, s35, v17
    v_xor_b32 v18, s35, v18
    v_xor_b32 v19, s35, v19
    v_or3_b32 v40, v16, v17, v18
    v_or_b32 v40, v40, v19
    s_waitcnt vmcnt(3)
    v_xor_b32 v20, s35, v20
    v_xor_b32 v21, s35, v21
    v_xor_b32 v22, s35, v22
    v_xor_b32 v23, s35, v23
    v_or3_b32 v40, v40, v20, v21
    v_or3_b32 v40, v40, v22, v23
    v_pk_add_f32 v[16:17], v[16:17], v[20:21]
    v_pk_add_f32 v[18:19], v[18:19], v[22:23]
    s_waitcnt vmcnt(2)
    v_xor_b32 v24, s35, v24
    v_xor_b32 v25, s35, v25
    v_xor_b32 v26, s35, v26
    v_xor_b32 v27, s35, v27
    v_or3_b32 v40, v40, v24, v25
    v_or3_b32 v40, v40, v26, v27
    v_pk_add_f32 v[16:17], v[16:17], v[24:25]
    v_pk_add_f32 v[18:19], v[18:19], v[26:27]
    s_waitcnt vmcnt(1)
    v_xor_b32 v28, s35, v28
    v_xor_b32 v29, s35, v29
    v_xor_b32 v30, s35, v30
    v_xor_b32 v31, s35, v31
    v_or3_b32 v40, v40, v28, v29
    v_or3_b32 v40, v40, v30, v31
    v_pk_add_f32 v[16:17], v[16:17], v[28:29]
    v_pk_add_f32 v[18:19], v[18:19], v[30:31]
    s_waitcnt vmcnt(0)
    v_xor_b32 v32, s35, v32
    v_xor_b32 v33, s35, v33
    v_xor_b32 v34, s35, v34
    v_xor_b32 v35, s35, v35
    v_or3_b32 v40, v40, v32, v33
    v_or3_b32 v40, v40, v34, v35
    v_pk_add_f32 v[16:17], v[16:17], v[32:33]
    v_pk_add_f32 v[18:19], v[18:19], v[34:35]
    v_and_b32 v40, 0xff, v40
    v_cmp_ne_u32 vcc, 0, v40
    s_cbranch_vccz B_FIN
    s_add_u32 s14, s14, 1
    s_cmp_lt_u32 s14, 200000
    s_cbranch_scc1 B_POLL3
B_FIN:
    v_cvt_pk_bf16_f32 v20, v16, v17
    v_cvt_pk_bf16_f32 v21, v18, v19
    buffer_store_dwordx2 v[20:21], v107, s[52:55], s13 offen sc0 sc1
    s_or_b32 s12, s2, s3
    s_cmp_lg_u32 s12, 0
    s_cbranch_scc1 B_END
    s_mov_b64 exec, 0x1
    buffer_store_dword v7, v6, s[48:51], s12 offen sc1
    s_mov_b64 exec, -1
B_END:
    s_endpgm
B_SLOWTILE:
    s_cmp_ge_u32 s3, 2
    s_cbranch_scc1 B_SLOW2
    v_mul_u32_u24 v102, 114688, v4
    v_min_u32 v103, 13, v3
    v_lshl_add_u32 v102, v103, 7, v102
    s_lshl_b32 s12, s3, 7
    s_and_b32 s13, s5, 8
    s_lshl_b32 s13, s13, 2
    s_add_u32 s12, s12, s13
    s_add_u32 s12, s12, 71
    s_mul_i32 s12, s12, 14336
    s_mul_i32 s13, s4, 1792
    s_add_u32 s12, s12, s13
    buffer_load_dword v103, v102, s[28:31], s12 offen
    s_waitcnt vmcnt(0)
B_SLOW2:
    s_barrier
    s_branch B_OWN
C_S1:
    s_lshl_b32 s6, s5, 3
    s_add_u32 s6, s6, s4
    s_and_b32 s10, s5, 3
    s_lshr_b32 s11, s5, 2
    s_lshl_b32 s12, s4, 2
    s_add_u32 s11, s11, s12
    s_lshl_b32 s12, s10, 5
    s_add_u32 s12, s12, s11
    s_lshl_b32 s9, s12, 10
    s_add_u32 s9, s9, 65536
    s_waitcnt lgkmcnt(0)
    s_cmp_lg_u32 s3, 7
    s_cbranch_scc1 C_NOPOIS
    v_mov_b32 v44, -1
    v_mov_b32 v45, -1
    v_mov_b32 v46, -1
    v_mov_b32 v47, -1
    buffer_store_dwordx4 v[44:47], v98, s[48:51], s9 offen sc1
C_NOPOIS:
    s_cmp_lg_u32 s3, 3
    s_cbranch_scc1 C_NOC3
    s_mul_i32 s8, s4, 14
    s_sub_u32 s13, 3, s8
    s_and_b32 s13, s13, 7
    s_and_b32 s14, s5, 8
    s_add_u32 s13, s13, s14
    s_and_b32 s14, s5, 7
    s_cmp_ge_u32 s13, 14
    s_cbranch_scc1 C_C3M
    s_add_u32 s8, s8, s13
    v_lshrrev_b32 v5, 3, v1
    v_lshlrev_b32 v5, 4, v5
    v_and_b32 v93, 7, v1
    v_add_u32 v5, v5, v93
    v_mul_u32_u24 v5, 114688, v5
    s_branch C_C3L
C_C3M:
    s_lshl_b32 s14, s14, 7
    s_add_u32 s14, s14, 103
    v_mul_u32_u24 v5, 114688, v4
    v_min_u32 v93, 13, v3
    v_lshl_add_u32 v5, v93, 7, v5
C_C3L:
    s_lshl_b32 s8, s8, 7
    s_mul_i32 s14, s14, 14336
    s_add_u32 s8, s8, s14
    buffer_load_dword v90, v5, s[28:31], s8 offen
C_NOC3:
    s_load_dword s34, s[48:49], 0
    s_load_dwordx2 s[44:45], s[0:1], 40
    s_getpc_b64 s[22:23]
    s_add_u32 s22, s22, tab_c@rel32@lo+4
    s_addc_u32 s23, s23, tab_c@rel32@hi+12
    s_lshl_b32 s21, s6, 2
    s_load_dword s20, s[22:23], s21
    s_lshl_b32 s21, s6, 3
    s_add_u32 s21, s21, s3
    s_lshl_b32 s21, s21, 3
    s_add_u32 s21, s21, 576
    s_load_dwordx2 s[26:27], s[22:23], s21
    v_lshrrev_b32 v92, 2, v1
    v_and_b32 v93, 3, v1
    v_and_b32 v94, 2, v4
    v_xor_b32 v93, v93, v94
    v_lshlrev_b32 v2, 11, v92
    v_lshl_add_u32 v2, v93, 4, v2
    v_xor_b32 v92, v3, v4
    v_lshlrev_b32 v5, 4, v92
    v_lshl_add_u32 v48, v4, 11, v5
    v_xor_b32 v49, 64, v48
    v_xor_b32 v50, 128, v48
    v_xor_b32 v51, 192, v48
    s_lshl_b32 s7, s3, 18
    s_lshl_b32 s8, s11, 6
    s_add_u32 s7, s7, s8
    s_lshl_b32 s8, s10, 15
    s_lshl_b32 s13, s3, 8
    s_add_u32 s8, s8, s13
    s_lshl_b32 s13, s3, 13
    s_mov_b32 m0, s13
    s_lshl_b32 s14, s3, 12
    s_add_u32 s14, s14, 65536
    v_bfe_u32 v93, v1, 2, 2
    v_lshl_add_u32 v94, v4, 3, v93
    v_lshlrev_b32 v94, 6, v94
    v_and_b32 v95, 3, v1
    v_lshl_add_u32 v94, v95, 3, v94
    v_and_b32 v95, 1, v4
    v_lshl_add_u32 v94, v95, 5, v94
    v_add_u32 v94, s13, v94
    v_xor_b32 v95, 32, v94
    s_and_b32 s15, s3, 3
    s_lshl_b32 s15, s15, 13
    v_add_u32 v99, s15, v98
    v_lshl_add_u32 v40, v3, 8, v5
    v_add_u32 v40, s14, v40
    v_xor_b32 v41, 64, v40
    v_xor_b32 v42, 128, v40
    v_xor_b32 v43, 192, v40
    v_lshrrev_b32 v92, 1, v4
    v_lshlrev_b32 v92, 10, v92
    v_and_b32 v93, 1, v4
    v_lshl_add_u32 v92, v93, 9, v92
    v_lshl_add_u32 v92, v3, 4, v92
    v_mov_b32 v8, 0
    v_mov_b32 v9, 0
    v_mov_b32 v10, 0
    v_mov_b32 v11, 0
    v_mov_b32 v12, 0
    v_mov_b32 v13, 0
    v_mov_b32 v14, 0
    v_mov_b32 v15, 0
    v_mul_u32_u24 v97, 114688, v4
    v_min_u32 v93, 13, v3
    v_lshl_add_u32 v97, v93, 7, v97
    s_cmp_lg_u32 s3, 7
    s_cbranch_scc1 C_NOPF
    s_mul_i32 s16, s12, 16
    s_add_u32 s16, s16, 4096
    s_waitcnt vmcnt(0) lgkmcnt(0)
    v_mov_b32 v7, s34
    v_add_u32 v7, 1, v7
    s_mov_b64 exec, 0x1
    buffer_store_dword v7, v6, s[48:51], s16 offen sc1
    s_mov_b64 exec, -1
C_NOPF:
    s_cmp_ge_u32 s3, 2
    s_cbranch_scc1 C_NOWW
    s_waitcnt vmcnt(0)
C_NOWW:
    s_barrier
    buffer_load_dwordx4 v2, s[36:39], s7 offen lds
    s_add_u32 m0, m0, 1024
    s_add_u32 s7, s7, 32768
    buffer_load_dwordx4 v2, s[36:39], s7 offen lds
    s_add_u32 m0, m0, 1024
    s_add_u32 s7, s7, 32768
    buffer_load_dwordx4 v2, s[36:39], s7 offen lds
    s_add_u32 m0, m0, 1024
    s_add_u32 s7, s7, 32768
    buffer_load_dwordx4 v2, s[36:39], s7 offen lds
    s_add_u32 m0, m0, 1024
    s_add_u32 s7, s7, 32768
    s_mov_b32 s16, m0
    s_mov_b32 m0, s14
    s_nop 0
    buffer_load_dwordx4 v48, s[40:43], s8 offen lds
    s_add_u32 m0, m0, 1024
    s_add_u32 s8, s8, 8192
    buffer_load_dwordx4 v49, s[40:43], s8 offen lds
    s_add_u32 m0, m0, 1024
    s_add_u32 s8, s8, 8192
    buffer_load_dwordx4 v50, s[40:43], s8 offen lds
    s_add_u32 m0, m0, 1024
    s_add_u32 s8, s8, 8192
    buffer_load_dwordx4 v51, s[40:43], s8 offen lds
    s_mov_b32 m0, s16
    s_nop 0
    buffer_load_dwordx4 v2, s[36:39], s7 offen lds
    s_add_u32 m0, m0, 1024
    s_add_u32 s7, s7, 32768
    buffer_load_dwordx4 v2, s[36:39], s7 offen lds
    s_add_u32 m0, m0, 1024
    s_add_u32 s7, s7, 32768
    buffer_load_dwordx4 v2, s[36:39], s7 offen lds
    s_add_u32 m0, m0, 1024
    s_add_u32 s7, s7, 32768
    buffer_load_dwordx4 v2, s[36:39], s7 offen lds
    s_cmp_lt_u32 s3, 4
    s_cbranch_scc1 C_S1MM
    s_barrier
    ds_read_b128 v[8:11], v99
    ds_read_b128 v[12:15], v99 offset:1024
C_S1MM:
    s_waitcnt vmcnt(4) lgkmcnt(0)
    ds_read_b128 v[24:27], v40
    ds_read_b128 v[28:31], v41
    ds_read_b128 v[32:35], v42
    ds_read_b128 v[36:39], v43
    ds_read_b64_tr_b16 v[100:101], v94 offset:0
    ds_read_b64_tr_b16 v[102:103], v94 offset:256
    ds_read_b64_tr_b16 v[104:105], v95 offset:0
    ds_read_b64_tr_b16 v[106:107], v95 offset:256
    ds_read_b64_tr_b16 v[108:109], v94 offset:2048
    ds_read_b64_tr_b16 v[110:111], v94 offset:2304
    ds_read_b64_tr_b16 v[112:113], v95 offset:2048
    ds_read_b64_tr_b16 v[114:115], v95 offset:2304
    s_waitcnt vmcnt(2) lgkmcnt(0)
    ds_read_b64_tr_b16 v[116:117], v94 offset:4096
    ds_read_b64_tr_b16 v[118:119], v94 offset:4352
    ds_read_b64_tr_b16 v[120:121], v95 offset:4096
    ds_read_b64_tr_b16 v[122:123], v95 offset:4352
    v_mfma_f32_16x16x32_bf16 v[8:11], v[100:103], v[24:27], v[8:11]
    v_mfma_f32_16x16x32_bf16 v[12:15], v[104:107], v[24:27], v[12:15]
    v_mfma_f32_16x16x32_bf16 v[8:11], v[108:111], v[28:31], v[8:11]
    v_mfma_f32_16x16x32_bf16 v[12:15], v[112:115], v[28:31], v[12:15]
    s_waitcnt vmcnt(0)
    ds_read_b64_tr_b16 v[124:125], v94 offset:6144
    ds_read_b64_tr_b16 v[126:127], v94 offset:6400
    ds_read_b64_tr_b16 v[128:129], v95 offset:6144
    ds_read_b64_tr_b16 v[130:131], v95 offset:6400
    s_waitcnt lgkmcnt(4)
    v_mfma_f32_16x16x32_bf16 v[8:11], v[116:119], v[32:35], v[8:11]
    v_mfma_f32_16x16x32_bf16 v[12:15], v[120:123], v[32:35], v[12:15]
    s_waitcnt lgkmcnt(0)
    v_mfma_f32_16x16x32_bf16 v[8:11], v[124:127], v[36:39], v[8:11]
    v_mfma_f32_16x16x32_bf16 v[12:15], v[128:131], v[36:39], v[12:15]
    s_nop 6
    ds_write_b128 v99, v[8:11]
    ds_write_b128 v99, v[12:15] offset:1024
    s_waitcnt lgkmcnt(0)
    s_barrier
    s_cmp_ge_u32 s3, 4
    s_cbranch_scc1 C_S1DONE
    s_barrier
    s_cmp_lg_u32 s3, 0
    s_cbranch_scc1 C_S1DONE
    ds_read_b128 v[100:103], v92 offset:0
    ds_read_b128 v[104:107], v92 offset:256
    ds_read_b128 v[108:111], v92 offset:8192
    ds_read_b128 v[112:115], v92 offset:8448
    ds_read_b128 v[116:119], v92 offset:16384
    ds_read_b128 v[120:123], v92 offset:16640
    ds_read_b128 v[124:127], v92 offset:24576
    ds_read_b128 v[128:131], v92 offset:24832
    s_waitcnt lgkmcnt(4)
    v_pk_add_f32 v[100:101], v[100:101], v[108:109]
    v_pk_add_f32 v[102:103], v[102:103], v[110:111]
    v_pk_add_f32 v[104:105], v[104:105], v[112:113]
    v_pk_add_f32 v[106:107], v[106:107], v[114:115]
    s_waitcnt lgkmcnt(2)
    v_pk_add_f32 v[100:101], v[100:101], v[116:117]
    v_pk_add_f32 v[102:103], v[102:103], v[118:119]
    v_pk_add_f32 v[104:105], v[104:105], v[120:121]
    v_pk_add_f32 v[106:107], v[106:107], v[122:123]
    s_waitcnt lgkmcnt(0)
    v_pk_add_f32 v[100:101], v[100:101], v[124:125]
    v_pk_add_f32 v[102:103], v[102:103], v[126:127]
    v_pk_add_f32 v[104:105], v[104:105], v[128:129]
    v_pk_add_f32 v[106:107], v[106:107], v[130:131]
    v_cvt_pk_bf16_f32 v44, v100, v101
    v_cvt_pk_bf16_f32 v45, v102, v103
    v_cvt_pk_bf16_f32 v46, v104, v105
    v_cvt_pk_bf16_f32 v47, v106, v107
    v_min_u32 v44, -2, v44
    v_min_u32 v45, -2, v45
    v_min_u32 v46, -2, v46
    v_min_u32 v47, -2, v47
    buffer_store_dwordx4 v[44:47], v98, s[48:51], s9 offen sc1
C_S1DONE:
    v_mul_u32_u24 v5, 114688, v4
    v_min_u32 v93, 13, v3
    v_lshl_add_u32 v5, v93, 7, v5
    s_barrier
    s_branch C_ITEMS
C_HELP:
    s_cmp_ge_u32 s5, 18
    s_cbranch_scc1 DONE
    s_lshl_b32 s6, s5, 3
    s_add_u32 s6, s6, s4
    s_waitcnt lgkmcnt(0)
    s_load_dword s34, s[48:49], 0
    s_load_dwordx2 s[44:45], s[0:1], 40
    s_getpc_b64 s[22:23]
    s_add_u32 s22, s22, tab_c@rel32@lo+4
    s_addc_u32 s23, s23, tab_c@rel32@hi+12
    s_lshl_b32 s21, s6, 2
    s_load_dword s20, s[22:23], s21
    s_lshl_b32 s21, s6, 3
    s_add_u32 s21, s21, s3
    s_lshl_b32 s21, s21, 3
    s_add_u32 s21, s21, 576
    s_load_dwordx2 s[26:27], s[22:23], s21
    v_mul_u32_u24 v5, 114688, v4
    v_min_u32 v93, 13, v3
    v_lshl_add_u32 v5, v93, 7, v5
C_ITEMS:
    s_waitcnt lgkmcnt(0)
    s_and_b32 s21, s26, 3
    s_cmp_lg_u32 s21, 1
    s_cbranch_scc1 C_ITEM0
    v_lshrrev_b32 v5, 3, v1
    v_lshlrev_b32 v5, 4, v5
    v_and_b32 v93, 7, v1
    v_add_u32 v5, v5, v93
    v_mul_u32_u24 v5, 114688, v5
    s_sub_u32 s26, s26, 1
C_ITEM0:
    s_mov_b32 s46, 0x1880000
    s_mov_b32 s47, 0x00020000
    s_cmp_eq_u32 s26, -1
    s_cbranch_scc1 C_ITEM2
    buffer_load_dword v90, v5, s[28:31], s26 offen
C_ITEM2:
    s_cmp_eq_u32 s27, -1
    s_cbranch_scc1 C_NOITEM
    s_cmp_lt_u32 s5, 16
    s_cbranch_scc1 C_ITEMV
    buffer_load_dword v91, v5, s[28:31], s27 offen
    s_branch C_NOITEM
C_ITEMV:
    v_mul_u32_u24 v5, 7168, v1
    buffer_load_dword v91, v5, s[44:47], s27 offen
C_NOITEM:
    s_cmp_ge_u32 s6, 140
    s_cbranch_scc1 DONE
    s_and_b32 s13, s20, 0xff
    s_bfe_u32 s14, s20, 0x80008
    s_bfe_u32 s16, s20, 0x80010
    s_lshr_b32 s15, s20, 24
    s_cmp_lt_u32 s14, 2
    s_cselect_b32 s17, 23, 22
    s_sub_u32 s18, s17, s16
    v_lshlrev_b32 v93, 2, v4
    v_xor_b32 v93, v93, v3
    v_lshlrev_b32 v93, 4, v93
    v_mul_u32_u24 v94, 7168, v4
    v_add_u32 v93, v93, v94
    s_add_u32 s57, s15, s16
    s_mul_i32 s57, s57, 229376
    s_mul_i32 s58, s3, 28672
    s_add_u32 s57, s57, s58
    s_lshl_b32 s58, s13, 8
    s_add_u32 s57, s57, s58
    s_mul_i32 s19, s17, 229376
    s_sub_u32 s19, s57, s19
    s_lshl_b32 s58, s3, 10
    s_add_u32 s58, s58, 98304
    s_barrier
    s_setprio 3
    s_cmp_gt_u32 s18, 0
    s_cselect_b32 s59, s57, s19
    s_add_u32 m0, s58, 0
    s_add_u32 s59, s59, 0
    buffer_load_dwordx4 v93, s[44:47], s59 offen nt lds
    s_cmp_gt_u32 s18, 1
    s_cselect_b32 s59, s57, s19
    s_add_u32 m0, s58, 8192
    s_add_u32 s59, s59, 229376
    buffer_load_dwordx4 v93, s[44:47], s59 offen nt lds
    s_setprio 2
    s_cmp_gt_u32 s18, 2
    s_cselect_b32 s59, s57, s19
    s_add_u32 m0, s58, 16384
    s_add_u32 s59, s59, 458752
    buffer_load_dwordx4 v93, s[44:47], s59 offen nt lds
    s_cmp_gt_u32 s18, 3
    s_cselect_b32 s59, s57, s19
    s_add_u32 m0, s58, 24576
    s_add_u32 s59, s59, 688128
    buffer_load_dwordx4 v93, s[44:47], s59 offen nt lds
    s_setprio 1
    s_cmp_gt_u32 s18, 4
    s_cselect_b32 s59, s57, s19
    s_add_u32 m0, s58, 32768
    s_add_u32 s59, s59, 917504
    buffer_load_dwordx4 v93, s[44:47], s59 offen nt lds
    s_cmp_gt_u32 s18, 5
    s_cselect_b32 s59, s57, s19
    s_add_u32 m0, s58, 40960
    s_add_u32 s59, s59, 1146880
    buffer_load_dwordx4 v93, s[44:47], s59 offen nt lds
    s_setprio 0
    s_cmp_lt_u32 s14, 2
    s_cselect_b32 s56, 0, 0x80000000
    v_or_b32 v94, s56, v93
    v_lshrrev_b32 v95, 5, v1
    v_lshlrev_b32 v95, 3, v95
    v_bfe_u32 v96, v1, 2, 2
    v_add_u32 v95, v95, v96
    v_lshlrev_b32 v95, 8, v95
    s_and_b32 s10, s3, 3
    v_xor_b32 v96, s10, v96
    v_lshl_add_u32 v95, v96, 6, v95
    v_and_b32 v96, 1, v1
    v_lshl_add_u32 v95, v96, 5, v95
    v_bfe_u32 v96, v1, 4, 1
    v_lshl_add_u32 v95, v96, 4, v95
    v_bfe_u32 v96, v1, 1, 1
    v_lshl_add_u32 v95, v96, 3, v95
    v_mov_b32 v97, v95
    v_add_u32 v95, 98304, v95
    s_add_u32 s59, s10, 0
    s_cmp_lt_u32 s59, s18
    s_cselect_b32 s21, 0, s17
    s_add_u32 s59, s59, s16
    s_sub_u32 s59, s59, s21
    s_add_u32 s59, s59, s15
    s_lshl_b32 s59, s59, 11
    s_add_u32 s36, s59, 262144
    s_add_u32 s59, s10, 4
    s_cmp_lt_u32 s59, s18
    s_cselect_b32 s21, 0, s17
    s_add_u32 s59, s59, s16
    s_sub_u32 s59, s59, s21
    s_add_u32 s59, s59, s15
    s_lshl_b32 s59, s59, 11
    s_add_u32 s37, s59, 262144
    s_add_u32 s59, s10, 8
    s_cmp_lt_u32 s59, s18
    s_cselect_b32 s21, 0, s17
    s_add_u32 s59, s59, s16
    s_sub_u32 s59, s59, s21
    s_add_u32 s59, s59, s15
    s_lshl_b32 s59, s59, 11
    s_add_u32 s38, s59, 262144
    s_add_u32 s59, s10, 12
    s_cmp_lt_u32 s59, s18
    s_cselect_b32 s21, 0, s17
    s_add_u32 s59, s59, s16
    s_sub_u32 s59, s59, s21
    s_add_u32 s59, s59, s15
    s_lshl_b32 s59, s59, 11
    s_add_u32 s39, s59, 262144
    s_add_u32 s59, s10, 16
    s_cmp_lt_u32 s59, s18
    s_cselect_b32 s21, 0, s17
    s_add_u32 s59, s59, s16
    s_sub_u32 s59, s59, s21
    s_add_u32 s59, s59, s15
    s_lshl_b32 s59, s59, 11
    s_add_u32 s40, s59, 262144
    s_add_u32 s59, s10, 20
    s_cmp_lt_u32 s59, s17
    s_cselect_b32 s56, 0, 0x80000000
    s_cmp_lt_u32 s59, s18
    s_cselect_b32 s21, 0, s17
    s_add_u32 s59, s59, s16
    s_sub_u32 s59, s59, s21
    s_add_u32 s59, s59, s15
    s_lshl_b32 s59, s59, 11
    s_add_u32 s41, s59, 262144
    v_or_b32 v96, s56, v98
    s_sub_u32 s59, s17, 1
    v_min_u32 v99, s59, v1
    v_add_u32 v99, s15, v99
    v_mul_u32_u24 v5, 16, v99
    v_lshlrev_b32 v99, 11, v99
    s_mov_b32 s7, 8192
    s_mov_b32 s9, 262400
    s_lshl_b32 s12, s10, 11
    s_lshr_b32 s11, s3, 2
    s_mul_i32 s59, s11, 49152
    v_add_u32 v2, s59, v98
    s_add_u32 s34, s34, 1
    v_mov_b32 v7, s34
    s_mul_i32 s8, s13, 5
    s_add_u32 s8, s8, s14
    s_lshl_b32 s8, s8, 3
    s_add_u32 s8, s8, s3
    s_lshl_b32 s8, s8, 12
    s_add_u32 s8, s8, 1048576
    s_waitcnt vmcnt(4)
    s_waitcnt lgkmcnt(0)
    s_barrier
    s_cmp_gt_u32 s18, 6
    s_cselect_b32 s59, s57, s19
    s_add_u32 m0, s58, 49152
    s_add_u32 s59, s59, 1376256
    buffer_load_dwordx4 v93, s[44:47], s59 offen nt lds
    s_cmp_gt_u32 s18, 7
    s_cselect_b32 s59, s57, s19
    s_add_u32 m0, s58, 57344
    s_add_u32 s59, s59, 1605632
    buffer_load_dwordx4 v93, s[44:47], s59 offen nt lds
    ds_read_b64_tr_b16 v[100:101], v95 offset:0
    ds_read_b64_tr_b16 v[102:103], v95 offset:1024
    ds_read_b64_tr_b16 v[104:105], v95 offset:4096
    ds_read_b64_tr_b16 v[106:107], v95 offset:5120
    ds_read_b64_tr_b16 v[108:109], v95 offset:8192
    ds_read_b64_tr_b16 v[110:111], v95 offset:9216
    ds_read_b64_tr_b16 v[112:113], v95 offset:12288
    ds_read_b64_tr_b16 v[114:115], v95 offset:13312
    s_cmp_lg_u32 s3, 0
    s_cbranch_scc1 C_NOKEEP
    s_mov_b64 exec, 0x7fffff
    buffer_load_dword v92, v5, s[48:51], s7 offen sc1
    s_mov_b64 exec, -1
    s_cmp_lt_u32 s5, 16
    s_cbranch_scc1 C_NOKEEP
    s_lshl_b32 s59, s6, 4
    s_add_u32 s59, s59, 10240
    s_mov_b64 exec, 0x1
    buffer_store_dword v7, v6, s[48:51], s59 offen sc1
    s_mov_b64 exec, -1
C_NOKEEP:
    s_waitcnt vmcnt(4)
    s_waitcnt lgkmcnt(0)
    s_barrier
    s_cmp_gt_u32 s18, 8
    s_cselect_b32 s59, s57, s19
    s_add_u32 m0, s58, 0
    s_add_u32 s59, s59, 1835008
    buffer_load_dwordx4 v93, s[44:47], s59 offen nt lds
    s_cmp_gt_u32 s18, 9
    s_cselect_b32 s59, s57, s19
    s_add_u32 m0, s58, 8192
    s_add_u32 s59, s59, 2064384
    buffer_load_dwordx4 v93, s[44:47], s59 offen nt lds
    ds_read_b64_tr_b16 v[116:117], v95 offset:16384
    ds_read_b64_tr_b16 v[118:119], v95 offset:17408
    ds_read_b64_tr_b16 v[120:121], v95 offset:20480
    ds_read_b64_tr_b16 v[122:123], v95 offset:21504
    ds_read_b64_tr_b16 v[124:125], v95 offset:24576
    ds_read_b64_tr_b16 v[126:127], v95 offset:25600
    ds_read_b64_tr_b16 v[128:129], v95 offset:28672
    ds_read_b64_tr_b16 v[130:131], v95 offset:29696
    s_waitcnt vmcnt(4)
    s_waitcnt lgkmcnt(0)
    s_barrier
    s_cmp_gt_u32 s18, 10
    s_cselect_b32 s59, s57, s19
    s_add_u32 m0, s58, 16384
    s_add_u32 s59, s59, 2293760
    buffer_load_dwordx4 v93, s[44:47], s59 offen nt lds
    s_cmp_gt_u32 s18, 11
    s_cselect_b32 s59, s57, s19
    s_add_u32 m0, s58, 24576
    s_add_u32 s59, s59, 2523136
    buffer_load_dwordx4 v93, s[44:47], s59 offen nt lds
    ds_read_b64_tr_b16 v[132:133], v95 offset:32768
    ds_read_b64_tr_b16 v[134:135], v95 offset:33792
    ds_read_b64_tr_b16 v[136:137], v95 offset:36864
    ds_read_b64_tr_b16 v[138:139], v95 offset:37888
    ds_read_b64_tr_b16 v[140:141], v95 offset:40960
    ds_read_b64_tr_b16 v[142:143], v95 offset:41984
    ds_read_b64_tr_b16 v[144:145], v95 offset:45056
    ds_read_b64_tr_b16 v[146:147], v95 offset:46080
    s_waitcnt vmcnt(4)
    s_waitcnt lgkmcnt(0)
    s_barrier
    s_cmp_gt_u32 s18, 12
    s_cselect_b32 s59, s57, s19
    s_add_u32 m0, s58, 32768
    s_add_u32 s59, s59, 2752512
    buffer_load_dwordx4 v93, s[44:47], s59 offen  lds
    s_cmp_gt_u32 s18, 13
    s_cselect_b32 s59, s57, s19
    s_add_u32 m0, s58, 40960
    s_add_u32 s59, s59, 2981888
    buffer_load_dwordx4 v93, s[44:47], s59 offen  lds
    ds_read_b64_tr_b16 v[148:149], v95 offset:49152
    ds_read_b64_tr_b16 v[150:151], v95 offset:50176
    ds_read_b64_tr_b16 v[152:153], v95 offset:53248
    ds_read_b64_tr_b16 v[154:155], v95 offset:54272
    ds_read_b64_tr_b16 v[156:157], v95 offset:57344
    ds_read_b64_tr_b16 v[158:159], v95 offset:58368
    ds_read_b64_tr_b16 v[160:161], v95 offset:61440
    ds_read_b64_tr_b16 v[162:163], v95 offset:62464
    s_waitcnt vmcnt(4)
    s_waitcnt lgkmcnt(0)
    s_barrier
    s_cmp_gt_u32 s18, 14
    s_cselect_b32 s59, s57, s19
    s_add_u32 m0, s58, 49152
    s_add_u32 s59, s59, 3211264
    buffer_load_dwordx4 v93, s[44:47], s59 offen  lds
    s_cmp_gt_u32 s18, 15
    s_cselect_b32 s59, s57, s19
    s_add_u32 m0, s58, 57344
    s_add_u32 s59, s59, 3440640
    buffer_load_dwordx4 v93, s[44:47], s59 offen  lds
    ds_read_b64_tr_b16 v[164:165], v95 offset:0
    ds_read_b64_tr_b16 v[166:167], v95 offset:1024
    ds_read_b64_tr_b16 v[168:169], v95 offset:4096
    ds_read_b64_tr_b16 v[170:171], v95 offset:5120
    ds_read_b64_tr_b16 v[172:173], v95 offset:8192
    ds_read_b64_tr_b16 v[174:175], v95 offset:9216
    ds_read_b64_tr_b16 v[176:177], v95 offset:12288
    ds_read_b64_tr_b16 v[178:179], v95 offset:13312
    s_waitcnt vmcnt(4)
    s_waitcnt lgkmcnt(0)
    s_barrier
    ds_read_b64_tr_b16 v[180:181], v95 offset:16384
    ds_read_b64_tr_b16 v[182:183], v95 offset:17408
    ds_read_b64_tr_b16 v[184:185], v95 offset:20480
    ds_read_b64_tr_b16 v[186:187], v95 offset:21504
    ds_read_b64_tr_b16 v[188:189], v95 offset:24576
    ds_read_b64_tr_b16 v[190:191], v95 offset:25600
    ds_read_b64_tr_b16 v[192:193], v95 offset:28672
    ds_read_b64_tr_b16 v[194:195], v95 offset:29696
    s_waitcnt vmcnt(2)
    s_waitcnt lgkmcnt(0)
    s_barrier
    ds_read_b64_tr_b16 v[196:197], v95 offset:32768
    ds_read_b64_tr_b16 v[198:199], v95 offset:33792
    ds_read_b64_tr_b16 v[200:201], v95 offset:36864
    ds_read_b64_tr_b16 v[202:203], v95 offset:37888
    ds_read_b64_tr_b16 v[204:205], v95 offset:40960
    ds_read_b64_tr_b16 v[206:207], v95 offset:41984
    ds_read_b64_tr_b16 v[208:209], v95 offset:45056
    ds_read_b64_tr_b16 v[210:211], v95 offset:46080
    s_waitcnt vmcnt(0)
    s_waitcnt lgkmcnt(0)
    s_barrier
    ds_read_b64_tr_b16 v[212:213], v95 offset:49152
    ds_read_b64_tr_b16 v[214:215], v95 offset:50176
    ds_read_b64_tr_b16 v[216:217], v95 offset:53248
    ds_read_b64_tr_b16 v[218:219], v95 offset:54272
    ds_read_b64_tr_b16 v[220:221], v95 offset:57344
    ds_read_b64_tr_b16 v[222:223], v95 offset:58368
    ds_read_b64_tr_b16 v[224:225], v95 offset:61440
    ds_read_b64_tr_b16 v[226:227], v95 offset:62464
    s_and_b32 s35, s34, 0xff
    s_movk_i32 s13, 0xff
    v_mov_b32 v7, s35
    s_cmp_lg_u32 s3, 0
    s_cbranch_scc1 C_H
    s_mov_b64 exec, 0x7fffff
    v_cmp_ne_u32 vcc, s34, v92
    s_cbranch_vccz C_PF2_OK
    s_mov_b32 s59, 0
C_PF2:
    buffer_load_dword v92, v5, s[48:51], s7 offen sc1
    s_waitcnt vmcnt(0)
    v_cmp_ne_u32 vcc, s34, v92
    s_cbranch_vccz C_PF2_OK
    s_sleep 4
    s_add_u32 s59, s59, 1
    s_cmp_lt_u32 s59, 200000
    s_cbranch_scc1 C_PF2
C_PF2_OK:
    s_mov_b32 s59, 0
C_POLL2:
    buffer_load_dword v88, v99, s[48:51], s9 offen sc1
    s_waitcnt vmcnt(0)
    v_cmp_eq_u32 vcc, -1, v88
    s_cbranch_vccz C_SEEN
    s_add_u32 s59, s59, 1
    s_cmp_lt_u32 s59, 200000
    s_cbranch_scc1 C_POLL2
C_SEEN:
    s_mov_b64 exec, -1
C_H:
    v_mov_b32 v99, 0
    s_waitcnt lgkmcnt(0)
    s_cmp_lg_u32 s11, 0
    s_cbranch_scc1 C_HI
    s_barrier
    s_add_u32 m0, s12, 0
    s_nop 0
    buffer_load_dwordx4 v98, s[48:51], s36 offen offset:0 sc1 lds
    buffer_load_dwordx4 v98, s[48:51], s36 offen offset:1024 sc1 lds
    s_waitcnt vmcnt(0)
    s_barrier
    ds_read_b128 v[24:27], v2 offset:0
    ds_read_b128 v[28:31], v2 offset:1024
    ds_read_b128 v[32:35], v2 offset:2048
    ds_read_b128 v[36:39], v2 offset:3072
    ds_read_b128 v[40:43], v2 offset:4096
    s_waitcnt lgkmcnt(4)
    v_mfma_f32_32x32x16_bf16 v[8:23], v[100:103], v[24:27], 0
    v_max3_u32 v99, v99, v24, v26
    ds_read_b128 v[44:47], v2 offset:5120
    s_waitcnt lgkmcnt(4)
    v_mfma_f32_32x32x16_bf16 v[8:23], v[104:107], v[28:31], v[8:23]
    v_max3_u32 v99, v99, v28, v30
    ds_read_b128 v[48:51], v2 offset:6144
    s_waitcnt lgkmcnt(4)
    v_mfma_f32_32x32x16_bf16 v[8:23], v[108:111], v[32:35], v[8:23]
    v_max3_u32 v99, v99, v32, v34
    ds_read_b128 v[52:55], v2 offset:7168
    s_waitcnt lgkmcnt(4)
    v_mfma_f32_32x32x16_bf16 v[8:23], v[112:115], v[36:39], v[8:23]
    v_max3_u32 v99, v99, v36, v38
    ds_read_b128 v[24:27], v2 offset:8192
    s_waitcnt lgkmcnt(4)
    v_mfma_f32_32x32x16_bf16 v[8:23], v[116:119], v[40:43], v[8:23]
    v_max3_u32 v99, v99, v40, v42
    ds_read_b128 v[28:31], v2 offset:9216
    s_waitcnt lgkmcnt(4)
    v_mfma_f32_32x32x16_bf16 v[8:23], v[120:123], v[44:47], v[8:23]
    v_max3_u32 v99, v99, v44, v46
    ds_read_b128 v[32:35], v2 offset:10240
    s_waitcnt lgkmcnt(4)
    v_mfma_f32_32x32x16_bf16 v[8:23], v[124:127], v[48:51], v[8:23]
    v_max3_u32 v99, v99, v48, v50
    ds_read_b128 v[36:39], v2 offset:11264
    s_waitcnt lgkmcnt(4)
    v_mfma_f32_32x32x16_bf16 v[8:23], v[128:131], v[52:55], v[8:23]
    v_max3_u32 v99, v99, v52, v54
    ds_read_b128 v[40:43], v2 offset:12288
    s_waitcnt lgkmcnt(4)
    v_mfma_f32_32x32x16_bf16 v[8:23], v[132:135], v[24:27], v[8:23]
    v_max3_u32 v99, v99, v24, v26
    ds_read_b128 v[44:47], v2 offset:13312
    s_waitcnt lgkmcnt(4)
    v_mfma_f32_32x32x16_bf16 v[8:23], v[136:139], v[28:31], v[8:23]
    v_max3_u32 v99, v99, v28, v30
    ds_read_b128 v[48:51], v2 offset:14336
    s_waitcnt lgkmcnt(4)
    v_mfma_f32_32x32x16_bf16 v[8:23], v[140:143], v[32:35], v[8:23]
    v_max3_u32 v99, v99, v32, v34
    ds_read_b128 v[52:55], v2 offset:15360
    s_waitcnt lgkmcnt(4)
    v_mfma_f32_32x32x16_bf16 v[8:23], v[144:147], v[36:39], v[8:23]
    v_max3_u32 v99, v99, v36, v38
    s_barrier
    ds_read_b128 v[24:27], v2 offset:16384
    s_waitcnt lgkmcnt(4)
    v_mfma_f32_32x32x16_bf16 v[8:23], v[148:151], v[40:43], v[8:23]
    v_max3_u32 v99, v99, v40, v42
    ds_read_b128 v[28:31], v2 offset:17408
    s_waitcnt lgkmcnt(4)
    v_mfma_f32_32x32x16_bf16 v[8:23], v[152:155], v[44:47], v[8:23]
    v_max3_u32 v99, v99, v44, v46
    ds_read_b128 v[32:35], v2 offset:18432
    s_waitcnt lgkmcnt(4)
    v_mfma_f32_32x32x16_bf16 v[8:23], v[156:159], v[48:51], v[8:23]
    v_max3_u32 v99, v99, v48, v50
    ds_read_b128 v[36:39], v2 offset:19456
    s_waitcnt lgkmcnt(4)
    v_mfma_f32_32x32x16_bf16 v[8:23], v[160:163], v[52:55], v[8:23]
    v_max3_u32 v99, v99, v52, v54
    ds_read_b128 v[40:43], v2 offset:20480
    s_waitcnt lgkmcnt(4)
    v_mfma_f32_32x32x16_bf16 v[8:23], v[164:167], v[24:27], v[8:23]
    v_max3_u32 v99, v99, v24, v26
    ds_read_b128 v[44:47], v2 offset:21504
    s_barrier
    s_cmp_gt_u32 s18, 16
    s_cselect_b32 s59, s57, s19
    s_add_u32 m0, s58, 0
    s_add_u32 s59, s59, 3670016
    buffer_load_dwordx4 v93, s[44:47], s59 offen nt lds
    s_add_u32 m0, m0, 4096
    s_add_u32 s59, s59, 114688
    buffer_load_dwordx4 v93, s[44:47], s59 offen nt lds
    s_cmp_gt_u32 s18, 17
    s_cselect_b32 s59, s57, s19
    s_add_u32 m0, s58, 8192
    s_add_u32 s59, s59, 3899392
    buffer_load_dwordx4 v93, s[44:47], s59 offen nt lds
    s_add_u32 m0, m0, 4096
    s_add_u32 s59, s59, 114688
    buffer_load_dwordx4 v93, s[44:47], s59 offen nt lds
    s_cmp_gt_u32 s18, 18
    s_cselect_b32 s59, s57, s19
    s_add_u32 m0, s58, 16384
    s_add_u32 s59, s59, 4128768
    buffer_load_dwordx4 v93, s[44:47], s59 offen nt lds
    s_add_u32 m0, m0, 4096
    s_add_u32 s59, s59, 114688
    buffer_load_dwordx4 v93, s[44:47], s59 offen nt lds
    s_cmp_gt_u32 s18, 19
    s_cselect_b32 s59, s57, s19
    s_add_u32 m0, s58, 24576
    s_add_u32 s59, s59, 4358144
    buffer_load_dwordx4 v93, s[44:47], s59 offen nt lds
    s_add_u32 m0, m0, 4096
    s_add_u32 s59, s59, 114688
    buffer_load_dwordx4 v93, s[44:47], s59 offen nt lds
    s_waitcnt lgkmcnt(4)
    v_mfma_f32_32x32x16_bf16 v[8:23], v[168:171], v[28:31], v[8:23]
    v_max3_u32 v99, v99, v28, v30
    ds_read_b128 v[48:51], v2 offset:22528
    s_waitcnt lgkmcnt(4)
    v_mfma_f32_32x32x16_bf16 v[8:23], v[172:175], v[32:35], v[8:23]
    v_max3_u32 v99, v99, v32, v34
    ds_read_b128 v[52:55], v2 offset:23552
    s_waitcnt lgkmcnt(4)
    v_mfma_f32_32x32x16_bf16 v[8:23], v[176:179], v[36:39], v[8:23]
    v_max3_u32 v99, v99, v36, v38
    ds_read_b128 v[24:27], v2 offset:24576
    s_waitcnt lgkmcnt(4)
    v_mfma_f32_32x32x16_bf16 v[8:23], v[180:183], v[40:43], v[8:23]
    v_max3_u32 v99, v99, v40, v42
    ds_read_b128 v[28:31], v2 offset:25600
    s_waitcnt lgkmcnt(4)
    v_mfma_f32_32x32x16_bf16 v[8:23], v[184:187], v[44:47], v[8:23]
    v_max3_u32 v99, v99, v44, v46
    ds_read_b128 v[32:35], v2 offset:26624
    s_waitcnt lgkmcnt(4)
    v_mfma_f32_32x32x16_bf16 v[8:23], v[188:191], v[48:51], v[8:23]
    v_max3_u32 v99, v99, v48, v50
    ds_read_b128 v[36:39], v2 offset:27648
    s_waitcnt lgkmcnt(4)
    v_mfma_f32_32x32x16_bf16 v[8:23], v[192:195], v[52:55], v[8:23]
    v_max3_u32 v99, v99, v52, v54
    ds_read_b128 v[40:43], v2 offset:28672
    s_waitcnt lgkmcnt(4)
    v_mfma_f32_32x32x16_bf16 v[8:23], v[196:199], v[24:27], v[8:23]
    v_max3_u32 v99, v99, v24, v26
    ds_read_b128 v[44:47], v2 offset:29696
    s_waitcnt lgkmcnt(4)
    v_mfma_f32_32x32x16_bf16 v[8:23], v[200:203], v[28:31], v[8:23]
    v_max3_u32 v99, v99, v28, v30
    ds_read_b128 v[48:51], v2 offset:30720
    s_waitcnt lgkmcnt(4)
    v_mfma_f32_32x32x16_bf16 v[8:23], v[204:207], v[32:35], v[8:23]
    v_max3_u32 v99, v99, v32, v34
    ds_read_b128 v[52:55], v2 offset:31744
    s_waitcnt lgkmcnt(4)
    v_mfma_f32_32x32x16_bf16 v[8:23], v[208:211], v[36:39], v[8:23]
    v_max3_u32 v99, v99, v36, v38
    s_barrier
    s_waitcnt vmcnt(4)
    s_barrier
    s_cmp_gt_u32 s18, 20
    s_cselect_b32 s59, s57, s19
    s_add_u32 m0, s58, 32768
    s_add_u32 s59, s59, 4587520
    buffer_load_dwordx4 v93, s[44:47], s59 offen nt lds
    s_cmp_gt_u32 s18, 21
    s_cselect_b32 s59, s57, s19
    s_add_u32 m0, s58, 40960
    s_add_u32 s59, s59, 4816896
    buffer_load_dwordx4 v93, s[44:47], s59 offen nt lds
    ds_read_b128 v[24:27], v2 offset:32768
    ds_read_b64_tr_b16 v[56:57], v95 offset:0
    ds_read_b64_tr_b16 v[58:59], v95 offset:1024
    s_waitcnt lgkmcnt(6)
    v_mfma_f32_32x32x16_bf16 v[8:23], v[212:215], v[40:43], v[8:23]
    v_max3_u32 v99, v99, v40, v42
    ds_read_b128 v[28:31], v2 offset:33792
    ds_read_b64_tr_b16 v[60:61], v95 offset:4096
    ds_read_b64_tr_b16 v[62:63], v95 offset:5120
    s_waitcnt lgkmcnt(8)
    v_mfma_f32_32x32x16_bf16 v[8:23], v[216:219], v[44:47], v[8:23]
    v_max3_u32 v99, v99, v44, v46
    ds_read_b128 v[32:35], v2 offset:34816
    ds_read_b64_tr_b16 v[64:65], v95 offset:8192
    ds_read_b64_tr_b16 v[66:67], v95 offset:9216
    s_waitcnt lgkmcnt(10)
    v_mfma_f32_32x32x16_bf16 v[8:23], v[220:223], v[48:51], v[8:23]
    v_max3_u32 v99, v99, v48, v50
    ds_read_b128 v[36:39], v2 offset:35840
    ds_read_b64_tr_b16 v[68:69], v95 offset:12288
    ds_read_b64_tr_b16 v[70:71], v95 offset:13312
    s_waitcnt lgkmcnt(12)
    v_mfma_f32_32x32x16_bf16 v[8:23], v[224:227], v[52:55], v[8:23]
    v_max3_u32 v99, v99, v52, v54
    s_waitcnt vmcnt(2)
    s_barrier
    s_cmp_gt_u32 s18, 22
    s_cselect_b32 s59, s57, s19
    s_add_u32 m0, s58, 49152
    s_add_u32 s59, s59, 5046272
    buffer_load_dwordx4 v94, s[44:47], s59 offen nt lds
    ds_read_b128 v[40:43], v2 offset:36864
    ds_read_b64_tr_b16 v[72:73], v95 offset:16384
    ds_read_b64_tr_b16 v[74:75], v95 offset:17408
    s_waitcnt lgkmcnt(12)
    v_mfma_f32_32x32x16_bf16 v[8:23], v[56:59], v[24:27], v[8:23]
    v_max3_u32 v99, v99, v24, v26
    ds_read_b128 v[44:47], v2 offset:37888
    ds_read_b64_tr_b16 v[76:77], v95 offset:20480
    ds_read_b64_tr_b16 v[78:79], v95 offset:21504
    s_waitcnt lgkmcnt(12)
    v_mfma_f32_32x32x16_bf16 v[8:23], v[60:63], v[28:31], v[8:23]
    v_max3_u32 v99, v99, v28, v30
    ds_read_b128 v[48:51], v2 offset:38912
    ds_read_b64_tr_b16 v[80:81], v95 offset:24576
    ds_read_b64_tr_b16 v[82:83], v95 offset:25600
    s_waitcnt lgkmcnt(12)
    v_mfma_f32_32x32x16_bf16 v[8:23], v[64:67], v[32:35], v[8:23]
    v_max3_u32 v99, v99, v32, v34
    ds_read_b128 v[52:55], v2 offset:39936
    ds_read_b64_tr_b16 v[84:85], v95 offset:28672
    ds_read_b64_tr_b16 v[86:87], v95 offset:29696
    s_waitcnt lgkmcnt(12)
    v_mfma_f32_32x32x16_bf16 v[8:23], v[68:71], v[36:39], v[8:23]
    v_max3_u32 v99, v99, v36, v38
    s_waitcnt vmcnt(1)
    s_barrier
    ds_read_b128 v[24:27], v2 offset:40960
    ds_read_b64_tr_b16 v[56:57], v95 offset:32768
    ds_read_b64_tr_b16 v[58:59], v95 offset:33792
    s_waitcnt lgkmcnt(12)
    v_mfma_f32_32x32x16_bf16 v[8:23], v[72:75], v[40:43], v[8:23]
    v_max3_u32 v99, v99, v40, v42
    ds_read_b128 v[28:31], v2 offset:41984
    ds_read_b64_tr_b16 v[60:61], v95 offset:36864
    ds_read_b64_tr_b16 v[62:63], v95 offset:37888
    s_waitcnt lgkmcnt(12)
    v_mfma_f32_32x32x16_bf16 v[8:23], v[76:79], v[44:47], v[8:23]
    v_max3_u32 v99, v99, v44, v46
    ds_read_b128 v[32:35], v2 offset:43008
    ds_read_b64_tr_b16 v[64:65], v95 offset:40960
    ds_read_b64_tr_b16 v[66:67], v95 offset:41984
    s_waitcnt lgkmcnt(12)
    v_mfma_f32_32x32x16_bf16 v[8:23], v[80:83], v[48:51], v[8:23]
    v_max3_u32 v99, v99, v48, v50
    ds_read_b128 v[36:39], v2 offset:44032
    ds_read_b64_tr_b16 v[68:69], v95 offset:45056
    ds_read_b64_tr_b16 v[70:71], v95 offset:46080
    s_waitcnt lgkmcnt(12)
    v_mfma_f32_32x32x16_bf16 v[8:23], v[84:87], v[52:55], v[8:23]
    v_max3_u32 v99, v99, v52, v54
    s_waitcnt vmcnt(0)
    s_barrier
    ds_read_b128 v[40:43], v2 offset:45056
    ds_read_b64_tr_b16 v[72:73], v95 offset:49152
    ds_read_b64_tr_b16 v[74:75], v95 offset:50176
    s_waitcnt lgkmcnt(12)
    v_mfma_f32_32x32x16_bf16 v[8:23], v[56:59], v[24:27], v[8:23]
    v_max3_u32 v99, v99, v24, v26
    ds_read_b128 v[44:47], v2 offset:46080
    ds_read_b64_tr_b16 v[76:77], v95 offset:53248
    ds_read_b64_tr_b16 v[78:79], v95 offset:54272
    s_waitcnt lgkmcnt(12)
    v_mfma_f32_32x32x16_bf16 v[8:23], v[60:63], v[28:31], v[8:23]
    v_max3_u32 v99, v99, v28, v30
    s_waitcnt lgkmcnt(9)
    v_mfma_f32_32x32x16_bf16 v[8:23], v[64:67], v[32:35], v[8:23]
    v_max3_u32 v99, v99, v32, v34
    s_waitcnt lgkmcnt(6)
    v_mfma_f32_32x32x16_bf16 v[8:23], v[68:71], v[36:39], v[8:23]
    v_max3_u32 v99, v99, v36, v38
    s_waitcnt lgkmcnt(3)
    v_mfma_f32_32x32x16_bf16 v[8:23], v[72:75], v[40:43], v[8:23]
    v_max3_u32 v99, v99, v40, v42
    s_waitcnt lgkmcnt(0)
    v_mfma_f32_32x32x16_bf16 v[8:23], v[76:79], v[44:47], v[8:23]
    v_max3_u32 v99, v99, v44, v46
    s_branch C_CHK
C_HI:
    s_barrier
    s_add_u32 m0, s12, 8192
    s_nop 0
    buffer_load_dwordx4 v98, s[48:51], s37 offen offset:0 sc1 lds
    buffer_load_dwordx4 v98, s[48:51], s37 offen offset:1024 sc1 lds
    s_add_u32 m0, s12, 16384
    s_nop 0
    buffer_load_dwordx4 v98, s[48:51], s38 offen offset:0 sc1 lds
    buffer_load_dwordx4 v98, s[48:51], s38 offen offset:1024 sc1 lds
    s_add_u32 m0, s12, 24576
    s_nop 0
    buffer_load_dwordx4 v98, s[48:51], s39 offen offset:0 sc1 lds
    buffer_load_dwordx4 v98, s[48:51], s39 offen offset:1024 sc1 lds
    s_add_u32 m0, s12, 32768
    s_nop 0
    buffer_load_dwordx4 v98, s[48:51], s40 offen offset:0 sc1 lds
    buffer_load_dwordx4 v98, s[48:51], s40 offen offset:1024 sc1 lds
    s_add_u32 m0, s12, 40960
    s_nop 0
    buffer_load_dwordx4 v96, s[48:51], s41 offen offset:0 sc1 lds
    buffer_load_dwordx4 v96, s[48:51], s41 offen offset:1024 sc1 lds
    s_waitcnt vmcnt(8)
    s_barrier
    s_add_u32 m0, s12, 49152
    s_add_u32 s59, s36, 229376
    buffer_load_dwordx4 v98, s[48:51], s59 offen offset:0 sc1 lds
    buffer_load_dwordx4 v98, s[48:51], s59 offen offset:1024 sc1 lds
    s_add_u32 m0, s12, 57344
    s_add_u32 s59, s37, 229376
    buffer_load_dwordx4 v98, s[48:51], s59 offen offset:0 sc1 lds
    buffer_load_dwordx4 v98, s[48:51], s59 offen offset:1024 sc1 lds
    s_add_u32 m0, s12, 65536
    s_add_u32 s59, s38, 229376
    buffer_load_dwordx4 v98, s[48:51], s59 offen offset:0 sc1 lds
    buffer_load_dwordx4 v98, s[48:51], s59 offen offset:1024 sc1 lds
    s_add_u32 m0, s12, 73728
    s_add_u32 s59, s39, 229376
    buffer_load_dwordx4 v98, s[48:51], s59 offen offset:0 sc1 lds
    buffer_load_dwordx4 v98, s[48:51], s59 offen offset:1024 sc1 lds
    s_waitcnt vmcnt(8)
    s_barrier
    s_add_u32 m0, s12, 81920
    s_add_u32 s59, s40, 229376
    buffer_load_dwordx4 v98, s[48:51], s59 offen offset:0 sc1 lds
    buffer_load_dwordx4 v98, s[48:51], s59 offen offset:1024 sc1 lds
    s_add_u32 m0, s12, 90112
    s_add_u32 s59, s41, 229376
    buffer_load_dwordx4 v96, s[48:51], s59 offen offset:0 sc1 lds
    buffer_load_dwordx4 v96, s[48:51], s59 offen offset:1024 sc1 lds
    s_waitcnt vmcnt(8)
    s_barrier
    ds_read_b128 v[24:27], v2 offset:0
    ds_read_b128 v[28:31], v2 offset:1024
    ds_read_b128 v[32:35], v2 offset:2048
    ds_read_b128 v[36:39], v2 offset:3072
    ds_read_b128 v[40:43], v2 offset:4096
    s_waitcnt lgkmcnt(4)
    v_mfma_f32_32x32x16_bf16 v[8:23], v[100:103], v[24:27], 0
    v_max3_u32 v99, v99, v24, v26
    ds_read_b128 v[44:47], v2 offset:5120
    s_waitcnt lgkmcnt(4)
    v_mfma_f32_32x32x16_bf16 v[8:23], v[104:107], v[28:31], v[8:23]
    v_max3_u32 v99, v99, v28, v30
    ds_read_b128 v[48:51], v2 offset:6144
    s_waitcnt lgkmcnt(4)
    v_mfma_f32_32x32x16_bf16 v[8:23], v[108:111], v[32:35], v[8:23]
    v_max3_u32 v99, v99, v32, v34
    ds_read_b128 v[52:55], v2 offset:7168
    s_waitcnt lgkmcnt(4)
    v_mfma_f32_32x32x16_bf16 v[8:23], v[112:115], v[36:39], v[8:23]
    v_max3_u32 v99, v99, v36, v38
    ds_read_b128 v[24:27], v2 offset:8192
    s_waitcnt lgkmcnt(4)
    v_mfma_f32_32x32x16_bf16 v[8:23], v[116:119], v[40:43], v[8:23]
    v_max3_u32 v99, v99, v40, v42
    ds_read_b128 v[28:31], v2 offset:9216
    s_waitcnt lgkmcnt(4)
    v_mfma_f32_32x32x16_bf16 v[8:23], v[120:123], v[44:47], v[8:23]
    v_max3_u32 v99, v99, v44, v46
    ds_read_b128 v[32:35], v2 offset:10240
    s_waitcnt lgkmcnt(4)
    v_mfma_f32_32x32x16_bf16 v[8:23], v[124:127], v[48:51], v[8:23]
    v_max3_u32 v99, v99, v48, v50
    ds_read_b128 v[36:39], v2 offset:11264
    s_waitcnt lgkmcnt(4)
    v_mfma_f32_32x32x16_bf16 v[8:23], v[128:131], v[52:55], v[8:23]
    v_max3_u32 v99, v99, v52, v54
    ds_read_b128 v[40:43], v2 offset:12288
    s_waitcnt lgkmcnt(4)
    v_mfma_f32_32x32x16_bf16 v[8:23], v[132:135], v[24:27], v[8:23]
    v_max3_u32 v99, v99, v24, v26
    ds_read_b128 v[44:47], v2 offset:13312
    s_waitcnt lgkmcnt(4)
    v_mfma_f32_32x32x16_bf16 v[8:23], v[136:139], v[28:31], v[8:23]
    v_max3_u32 v99, v99, v28, v30
    ds_read_b128 v[48:51], v2 offset:14336
    s_waitcnt lgkmcnt(4)
    v_mfma_f32_32x32x16_bf16 v[8:23], v[140:143], v[32:35], v[8:23]
    v_max3_u32 v99, v99, v32, v34
    ds_read_b128 v[52:55], v2 offset:15360
    s_waitcnt lgkmcnt(4)
    v_mfma_f32_32x32x16_bf16 v[8:23], v[144:147], v[36:39], v[8:23]
    v_max3_u32 v99, v99, v36, v38
    s_waitcnt vmcnt(0)
    s_barrier
    ds_read_b128 v[24:27], v2 offset:16384
    s_waitcnt lgkmcnt(4)
    v_mfma_f32_32x32x16_bf16 v[8:23], v[148:151], v[40:43], v[8:23]
    v_max3_u32 v99, v99, v40, v42
    ds_read_b128 v[28:31], v2 offset:17408
    s_waitcnt lgkmcnt(4)
    v_mfma_f32_32x32x16_bf16 v[8:23], v[152:155], v[44:47], v[8:23]
    v_max3_u32 v99, v99, v44, v46
    ds_read_b128 v[32:35], v2 offset:18432
    s_waitcnt lgkmcnt(4)
    v_mfma_f32_32x32x16_bf16 v[8:23], v[156:159], v[48:51], v[8:23]
    v_max3_u32 v99, v99, v48, v50
    ds_read_b128 v[36:39], v2 offset:19456
    s_waitcnt lgkmcnt(4)
    v_mfma_f32_32x32x16_bf16 v[8:23], v[160:163], v[52:55], v[8:23]
    v_max3_u32 v99, v99, v52, v54
    ds_read_b128 v[40:43], v2 offset:20480
    s_waitcnt lgkmcnt(4)
    v_mfma_f32_32x32x16_bf16 v[8:23], v[164:167], v[24:27], v[8:23]
    v_max3_u32 v99, v99, v24, v26
    ds_read_b128 v[44:47], v2 offset:21504
    s_waitcnt lgkmcnt(4)
    v_mfma_f32_32x32x16_bf16 v[8:23], v[168:171], v[28:31], v[8:23]
    v_max3_u32 v99, v99, v28, v30
    ds_read_b128 v[48:51], v2 offset:22528
    s_waitcnt lgkmcnt(4)
    v_mfma_f32_32x32x16_bf16 v[8:23], v[172:175], v[32:35], v[8:23]
    v_max3_u32 v99, v99, v32, v34
    ds_read_b128 v[52:55], v2 offset:23552
    s_waitcnt lgkmcnt(4)
    v_mfma_f32_32x32x16_bf16 v[8:23], v[176:179], v[36:39], v[8:23]
    v_max3_u32 v99, v99, v36, v38
    ds_read_b128 v[24:27], v2 offset:24576
    s_waitcnt lgkmcnt(4)
    v_mfma_f32_32x32x16_bf16 v[8:23], v[180:183], v[40:43], v[8:23]
    v_max3_u32 v99, v99, v40, v42
    ds_read_b128 v[28:31], v2 offset:25600
    s_waitcnt lgkmcnt(4)
    v_mfma_f32_32x32x16_bf16 v[8:23], v[184:187], v[44:47], v[8:23]
    v_max3_u32 v99, v99, v44, v46
    ds_read_b128 v[32:35], v2 offset:26624
    s_waitcnt lgkmcnt(4)
    v_mfma_f32_32x32x16_bf16 v[8:23], v[188:191], v[48:51], v[8:23]
    v_max3_u32 v99, v99, v48, v50
    ds_read_b128 v[36:39], v2 offset:27648
    s_waitcnt lgkmcnt(4)
    v_mfma_f32_32x32x16_bf16 v[8:23], v[192:195], v[52:55], v[8:23]
    v_max3_u32 v99, v99, v52, v54
    ds_read_b128 v[40:43], v2 offset:28672
    s_waitcnt lgkmcnt(4)
    v_mfma_f32_32x32x16_bf16 v[8:23], v[196:199], v[24:27], v[8:23]
    v_max3_u32 v99, v99, v24, v26
    ds_read_b128 v[44:47], v2 offset:29696
    s_waitcnt lgkmcnt(4)
    v_mfma_f32_32x32x16_bf16 v[8:23], v[200:203], v[28:31], v[8:23]
    v_max3_u32 v99, v99, v28, v30
    ds_read_b128 v[48:51], v2 offset:30720
    s_waitcnt lgkmcnt(4)
    v_mfma_f32_32x32x16_bf16 v[8:23], v[204:207], v[32:35], v[8:23]
    v_max3_u32 v99, v99, v32, v34
    ds_read_b128 v[52:55], v2 offset:31744
    s_waitcnt lgkmcnt(4)
    v_mfma_f32_32x32x16_bf16 v[8:23], v[208:211], v[36:39], v[8:23]
    v_max3_u32 v99, v99, v36, v38
    s_barrier
    s_cmp_gt_u32 s18, 20
    s_cselect_b32 s59, s57, s19
    s_add_u32 m0, s58, 32768
    s_add_u32 s59, s59, 4587520
    buffer_load_dwordx4 v93, s[44:47], s59 offen nt lds
    s_cmp_gt_u32 s18, 21
    s_cselect_b32 s59, s57, s19
    s_add_u32 m0, s58, 40960
    s_add_u32 s59, s59, 4816896
    buffer_load_dwordx4 v93, s[44:47], s59 offen nt lds
    ds_read_b128 v[24:27], v2 offset:32768
    ds_read_b64_tr_b16 v[56:57], v95 offset:0
    ds_read_b64_tr_b16 v[58:59], v95 offset:1024
    s_waitcnt lgkmcnt(6)
    v_mfma_f32_32x32x16_bf16 v[8:23], v[212:215], v[40:43], v[8:23]
    v_max3_u32 v99, v99, v40, v42
    ds_read_b128 v[28:31], v2 offset:33792
    ds_read_b64_tr_b16 v[60:61], v95 offset:4096
    ds_read_b64_tr_b16 v[62:63], v95 offset:5120
    s_waitcnt lgkmcnt(8)
    v_mfma_f32_32x32x16_bf16 v[8:23], v[216:219], v[44:47], v[8:23]
    v_max3_u32 v99, v99, v44, v46
    ds_read_b128 v[32:35], v2 offset:34816
    ds_read_b64_tr_b16 v[64:65], v95 offset:8192
    ds_read_b64_tr_b16 v[66:67], v95 offset:9216
    s_waitcnt lgkmcnt(10)
    v_mfma_f32_32x32x16_bf16 v[8:23], v[220:223], v[48:51], v[8:23]
    v_max3_u32 v99, v99, v48, v50
    ds_read_b128 v[36:39], v2 offset:35840
    ds_read_b64_tr_b16 v[68:69], v95 offset:12288
    ds_read_b64_tr_b16 v[70:71], v95 offset:13312
    s_waitcnt lgkmcnt(12)
    v_mfma_f32_32x32x16_bf16 v[8:23], v[224:227], v[52:55], v[8:23]
    v_max3_u32 v99, v99, v52, v54
    s_barrier
    s_cmp_gt_u32 s18, 22
    s_cselect_b32 s59, s57, s19
    s_add_u32 m0, s58, 49152
    s_add_u32 s59, s59, 5046272
    buffer_load_dwordx4 v94, s[44:47], s59 offen nt lds
    ds_read_b128 v[40:43], v2 offset:36864
    ds_read_b64_tr_b16 v[72:73], v95 offset:16384
    ds_read_b64_tr_b16 v[74:75], v95 offset:17408
    s_waitcnt lgkmcnt(12)
    v_mfma_f32_32x32x16_bf16 v[8:23], v[56:59], v[24:27], v[8:23]
    v_max3_u32 v99, v99, v24, v26
    ds_read_b128 v[44:47], v2 offset:37888
    ds_read_b64_tr_b16 v[76:77], v95 offset:20480
    ds_read_b64_tr_b16 v[78:79], v95 offset:21504
    s_waitcnt lgkmcnt(12)
    v_mfma_f32_32x32x16_bf16 v[8:23], v[60:63], v[28:31], v[8:23]
    v_max3_u32 v99, v99, v28, v30
    ds_read_b128 v[48:51], v2 offset:38912
    ds_read_b64_tr_b16 v[80:81], v95 offset:24576
    ds_read_b64_tr_b16 v[82:83], v95 offset:25600
    s_waitcnt lgkmcnt(12)
    v_mfma_f32_32x32x16_bf16 v[8:23], v[64:67], v[32:35], v[8:23]
    v_max3_u32 v99, v99, v32, v34
    ds_read_b128 v[52:55], v2 offset:39936
    ds_read_b64_tr_b16 v[84:85], v95 offset:28672
    ds_read_b64_tr_b16 v[86:87], v95 offset:29696
    s_waitcnt lgkmcnt(12)
    v_mfma_f32_32x32x16_bf16 v[8:23], v[68:71], v[36:39], v[8:23]
    v_max3_u32 v99, v99, v36, v38
    s_waitcnt vmcnt(1)
    s_barrier
    ds_read_b128 v[24:27], v2 offset:40960
    ds_read_b64_tr_b16 v[56:57], v95 offset:32768
    ds_read_b64_tr_b16 v[58:59], v95 offset:33792
    s_waitcnt lgkmcnt(12)
    v_mfma_f32_32x32x16_bf16 v[8:23], v[72:75], v[40:43], v[8:23]
    v_max3_u32 v99, v99, v40, v42
    ds_read_b128 v[28:31], v2 offset:41984
    ds_read_b64_tr_b16 v[60:61], v95 offset:36864
    ds_read_b64_tr_b16 v[62:63], v95 offset:37888
    s_waitcnt lgkmcnt(12)
    v_mfma_f32_32x32x16_bf16 v[8:23], v[76:79], v[44:47], v[8:23]
    v_max3_u32 v99, v99, v44, v46
    ds_read_b128 v[32:35], v2 offset:43008
    ds_read_b64_tr_b16 v[64:65], v95 offset:40960
    ds_read_b64_tr_b16 v[66:67], v95 offset:41984
    s_waitcnt lgkmcnt(12)
    v_mfma_f32_32x32x16_bf16 v[8:23], v[80:83], v[48:51], v[8:23]
    v_max3_u32 v99, v99, v48, v50
    ds_read_b128 v[36:39], v2 offset:44032
    ds_read_b64_tr_b16 v[68:69], v95 offset:45056
    ds_read_b64_tr_b16 v[70:71], v95 offset:46080
    s_waitcnt lgkmcnt(12)
    v_mfma_f32_32x32x16_bf16 v[8:23], v[84:87], v[52:55], v[8:23]
    v_max3_u32 v99, v99, v52, v54
    s_waitcnt vmcnt(0)
    s_barrier
    ds_read_b128 v[40:43], v2 offset:45056
    ds_read_b64_tr_b16 v[72:73], v95 offset:49152
    ds_read_b64_tr_b16 v[74:75], v95 offset:50176
    s_waitcnt lgkmcnt(12)
    v_mfma_f32_32x32x16_bf16 v[8:23], v[56:59], v[24:27], v[8:23]
    v_max3_u32 v99, v99, v24, v26
    ds_read_b128 v[44:47], v2 offset:46080
    ds_read_b64_tr_b16 v[76:77], v95 offset:53248
    ds_read_b64_tr_b16 v[78:79], v95 offset:54272
    s_waitcnt lgkmcnt(12)
    v_mfma_f32_32x32x16_bf16 v[8:23], v[60:63], v[28:31], v[8:23]
    v_max3_u32 v99, v99, v28, v30
    s_waitcnt lgkmcnt(9)
    v_mfma_f32_32x32x16_bf16 v[8:23], v[64:67], v[32:35], v[8:23]
    v_max3_u32 v99, v99, v32, v34
    s_waitcnt lgkmcnt(6)
    v_mfma_f32_32x32x16_bf16 v[8:23], v[68:71], v[36:39], v[8:23]
    v_max3_u32 v99, v99, v36, v38
    s_waitcnt lgkmcnt(3)
    v_mfma_f32_32x32x16_bf16 v[8:23], v[72:75], v[40:43], v[8:23]
    v_max3_u32 v99, v99, v40, v42
    s_waitcnt lgkmcnt(0)
    v_mfma_f32_32x32x16_bf16 v[8:23], v[76:79], v[44:47], v[8:23]
    v_max3_u32 v99, v99, v44, v46
C_CHK:
    v_cmp_eq_u32 vcc, -1, v99
    s_cbranch_vccnz C_SLOW
C_OUT:
    s_nop 8
    v_bfi_b32 v8, s13, v7, v8
    v_bfi_b32 v9, s13, v7, v9
    v_bfi_b32 v10, s13, v7, v10
    v_bfi_b32 v11, s13, v7, v11
    buffer_store_dwordx4 v[8:11], v98, s[48:51], s8 offen offset:0 sc1
    v_bfi_b32 v12, s13, v7, v12
    v_bfi_b32 v13, s13, v7, v13
    v_bfi_b32 v14, s13, v7, v14
    v_bfi_b32 v15, s13, v7, v15
    buffer_store_dwordx4 v[12:15], v98, s[48:51], s8 offen offset:1024 sc1
    v_bfi_b32 v16, s13, v7, v16
    v_bfi_b32 v17, s13, v7, v17
    v_bfi_b32 v18, s13, v7, v18
    v_bfi_b32 v19, s13, v7, v19
    buffer_store_dwordx4 v[16:19], v98, s[48:51], s8 offen offset:2048 sc1
    v_bfi_b32 v20, s13, v7, v20
    v_bfi_b32 v21, s13, v7, v21
    v_bfi_b32 v22, s13, v7, v22
    v_bfi_b32 v23, s13, v7, v23
    buffer_store_dwordx4 v[20:23], v98, s[48:51], s8 offen offset:3072 sc1
C_FLUSH:
DONE:
    s_endpgm
CODE_END:
C_SLOW:
    s_add_u32 s9, s15, s16
    s_lshl_b32 s9, s9, 11
    s_mul_i32 s7, s11, 229376
    s_add_u32 s9, s9, s7
    s_add_u32 s9, s9, 262144
    s_lshl_b32 s7, s17, 11
    s_sub_u32 s7, s9, s7
    v_and_b32 v5, 0x80000000, v94
    v_or_b32 v5, v5, v98
    s_mov_b32 s10, 0
C_SL_2:
    s_cmp_gt_u32 s18, 0
    s_cselect_b32 s59, s9, s7
    s_add_u32 s59, s59, 0
    buffer_load_dwordx4 v[24:27], v98, s[48:51], s59 offen offset:0 sc1
    buffer_load_dwordx4 v[28:31], v98, s[48:51], s59 offen offset:1024 sc1
    s_cmp_gt_u32 s18, 1
    s_cselect_b32 s59, s9, s7
    s_add_u32 s59, s59, 2048
    buffer_load_dwordx4 v[32:35], v98, s[48:51], s59 offen offset:0 sc1
    buffer_load_dwordx4 v[36:39], v98, s[48:51], s59 offen offset:1024 sc1
    s_cmp_gt_u32 s18, 2
    s_cselect_b32 s59, s9, s7
    s_add_u32 s59, s59, 4096
    buffer_load_dwordx4 v[40:43], v98, s[48:51], s59 offen offset:0 sc1
    buffer_load_dwordx4 v[44:47], v98, s[48:51], s59 offen offset:1024 sc1
    s_cmp_gt_u32 s18, 3
    s_cselect_b32 s59, s9, s7
    s_add_u32 s59, s59, 6144
    buffer_load_dwordx4 v[48:51], v98, s[48:51], s59 offen offset:0 sc1
    buffer_load_dwordx4 v[52:55], v98, s[48:51], s59 offen offset:1024 sc1
    v_mov_b32 v99, 0
    s_waitcnt vmcnt(0)
    v_max3_u32 v99, v99, v24, v25
    v_max3_u32 v99, v99, v26, v27
    v_max3_u32 v99, v99, v28, v29
    v_max3_u32 v99, v99, v30, v31
    v_max3_u32 v99, v99, v32, v33
    v_max3_u32 v99, v99, v34, v35
    v_max3_u32 v99, v99, v36, v37
    v_max3_u32 v99, v99, v38, v39
    v_max3_u32 v99, v99, v40, v41
    v_max3_u32 v99, v99, v42, v43
    v_max3_u32 v99, v99, v44, v45
    v_max3_u32 v99, v99, v46, v47
    v_max3_u32 v99, v99, v48, v49
    v_max3_u32 v99, v99, v50, v51
    v_max3_u32 v99, v99, v52, v53
    v_max3_u32 v99, v99, v54, v55
    v_cmp_eq_u32 vcc, -1, v99
    s_cbranch_vccz C_SL_2_OK
    s_sleep 2
    s_add_u32 s10, s10, 1
    s_cmp_lt_u32 s10, 200000
    s_cbranch_scc1 C_SL_2
C_SL_2_OK:
    v_mfma_f32_32x32x16_bf16 v[8:23], v[100:103], v[24:27], 0
    v_mfma_f32_32x32x16_bf16 v[8:23], v[104:107], v[28:31], v[8:23]
    v_mfma_f32_32x32x16_bf16 v[8:23], v[108:111], v[32:35], v[8:23]
    v_mfma_f32_32x32x16_bf16 v[8:23], v[112:115], v[36:39], v[8:23]
    v_mfma_f32_32x32x16_bf16 v[8:23], v[116:119], v[40:43], v[8:23]
    v_mfma_f32_32x32x16_bf16 v[8:23], v[120:123], v[44:47], v[8:23]
    v_mfma_f32_32x32x16_bf16 v[8:23], v[124:127], v[48:51], v[8:23]
    v_mfma_f32_32x32x16_bf16 v[8:23], v[128:131], v[52:55], v[8:23]
    s_nop 15
C_SL_3:
    s_cmp_gt_u32 s18, 4
    s_cselect_b32 s59, s9, s7
    s_add_u32 s59, s59, 8192
    buffer_load_dwordx4 v[24:27], v98, s[48:51], s59 offen offset:0 sc1
    buffer_load_dwordx4 v[28:31], v98, s[48:51], s59 offen offset:1024 sc1
    s_cmp_gt_u32 s18, 5
    s_cselect_b32 s59, s9, s7
    s_add_u32 s59, s59, 10240
    buffer_load_dwordx4 v[32:35], v98, s[48:51], s59 offen offset:0 sc1
    buffer_load_dwordx4 v[36:39], v98, s[48:51], s59 offen offset:1024 sc1
    s_cmp_gt_u32 s18, 6
    s_cselect_b32 s59, s9, s7
    s_add_u32 s59, s59, 12288
    buffer_load_dwordx4 v[40:43], v98, s[48:51], s59 offen offset:0 sc1
    buffer_load_dwordx4 v[44:47], v98, s[48:51], s59 offen offset:1024 sc1
    s_cmp_gt_u32 s18, 7
    s_cselect_b32 s59, s9, s7
    s_add_u32 s59, s59, 14336
    buffer_load_dwordx4 v[48:51], v98, s[48:51], s59 offen offset:0 sc1
    buffer_load_dwordx4 v[52:55], v98, s[48:51], s59 offen offset:1024 sc1
    v_mov_b32 v99, 0
    s_waitcnt vmcnt(0)
    v_max3_u32 v99, v99, v24, v25
    v_max3_u32 v99, v99, v26, v27
    v_max3_u32 v99, v99, v28, v29
    v_max3_u32 v99, v99, v30, v31
    v_max3_u32 v99, v99, v32, v33
    v_max3_u32 v99, v99, v34, v35
    v_max3_u32 v99, v99, v36, v37
    v_max3_u32 v99, v99, v38, v39
    v_max3_u32 v99, v99, v40, v41
    v_max3_u32 v99, v99, v42, v43
    v_max3_u32 v99, v99, v44, v45
    v_max3_u32 v99, v99, v46, v47
    v_max3_u32 v99, v99, v48, v49
    v_max3_u32 v99, v99, v50, v51
    v_max3_u32 v99, v99, v52, v53
    v_max3_u32 v99, v99, v54, v55
    v_cmp_eq_u32 vcc, -1, v99
    s_cbranch_vccz C_SL_3_OK
    s_sleep 2
    s_add_u32 s10, s10, 1
    s_cmp_lt_u32 s10, 200000
    s_cbranch_scc1 C_SL_3
C_SL_3_OK:
    v_mfma_f32_32x32x16_bf16 v[8:23], v[132:135], v[24:27], v[8:23]
    v_mfma_f32_32x32x16_bf16 v[8:23], v[136:139], v[28:31], v[8:23]
    v_mfma_f32_32x32x16_bf16 v[8:23], v[140:143], v[32:35], v[8:23]
    v_mfma_f32_32x32x16_bf16 v[8:23], v[144:147], v[36:39], v[8:23]
    v_mfma_f32_32x32x16_bf16 v[8:23], v[148:151], v[40:43], v[8:23]
    v_mfma_f32_32x32x16_bf16 v[8:23], v[152:155], v[44:47], v[8:23]
    v_mfma_f32_32x32x16_bf16 v[8:23], v[156:159], v[48:51], v[8:23]
    v_mfma_f32_32x32x16_bf16 v[8:23], v[160:163], v[52:55], v[8:23]
    s_nop 15
C_SL_4:
    s_cmp_gt_u32 s18, 8
    s_cselect_b32 s59, s9, s7
    s_add_u32 s59, s59, 16384
    buffer_load_dwordx4 v[24:27], v98, s[48:51], s59 offen offset:0 sc1
    buffer_load_dwordx4 v[28:31], v98, s[48:51], s59 offen offset:1024 sc1
    s_cmp_gt_u32 s18, 9
    s_cselect_b32 s59, s9, s7
    s_add_u32 s59, s59, 18432
    buffer_load_dwordx4 v[32:35], v98, s[48:51], s59 offen offset:0 sc1
    buffer_load_dwordx4 v[36:39], v98, s[48:51], s59 offen offset:1024 sc1
    s_cmp_gt_u32 s18, 10
    s_cselect_b32 s59, s9, s7
    s_add_u32 s59, s59, 20480
    buffer_load_dwordx4 v[40:43], v98, s[48:51], s59 offen offset:0 sc1
    buffer_load_dwordx4 v[44:47], v98, s[48:51], s59 offen offset:1024 sc1
    s_cmp_gt_u32 s18, 11
    s_cselect_b32 s59, s9, s7
    s_add_u32 s59, s59, 22528
    buffer_load_dwordx4 v[48:51], v98, s[48:51], s59 offen offset:0 sc1
    buffer_load_dwordx4 v[52:55], v98, s[48:51], s59 offen offset:1024 sc1
    v_mov_b32 v99, 0
    s_waitcnt vmcnt(0)
    v_max3_u32 v99, v99, v24, v25
    v_max3_u32 v99, v99, v26, v27
    v_max3_u32 v99, v99, v28, v29
    v_max3_u32 v99, v99, v30, v31
    v_max3_u32 v99, v99, v32, v33
    v_max3_u32 v99, v99, v34, v35
    v_max3_u32 v99, v99, v36, v37
    v_max3_u32 v99, v99, v38, v39
    v_max3_u32 v99, v99, v40, v41
    v_max3_u32 v99, v99, v42, v43
    v_max3_u32 v99, v99, v44, v45
    v_max3_u32 v99, v99, v46, v47
    v_max3_u32 v99, v99, v48, v49
    v_max3_u32 v99, v99, v50, v51
    v_max3_u32 v99, v99, v52, v53
    v_max3_u32 v99, v99, v54, v55
    v_cmp_eq_u32 vcc, -1, v99
    s_cbranch_vccz C_SL_4_OK
    s_sleep 2
    s_add_u32 s10, s10, 1
    s_cmp_lt_u32 s10, 200000
    s_cbranch_scc1 C_SL_4
C_SL_4_OK:
    v_mfma_f32_32x32x16_bf16 v[8:23], v[164:167], v[24:27], v[8:23]
    v_mfma_f32_32x32x16_bf16 v[8:23], v[168:171], v[28:31], v[8:23]
    v_mfma_f32_32x32x16_bf16 v[8:23], v[172:175], v[32:35], v[8:23]
    v_mfma_f32_32x32x16_bf16 v[8:23], v[176:179], v[36:39], v[8:23]
    v_mfma_f32_32x32x16_bf16 v[8:23], v[180:183], v[40:43], v[8:23]
    v_mfma_f32_32x32x16_bf16 v[8:23], v[184:187], v[44:47], v[8:23]
    v_mfma_f32_32x32x16_bf16 v[8:23], v[188:191], v[48:51], v[8:23]
    v_mfma_f32_32x32x16_bf16 v[8:23], v[192:195], v[52:55], v[8:23]
    s_nop 15
C_SL_5:
    s_cmp_gt_u32 s18, 12
    s_cselect_b32 s59, s9, s7
    s_add_u32 s59, s59, 24576
    buffer_load_dwordx4 v[24:27], v98, s[48:51], s59 offen offset:0 sc1
    buffer_load_dwordx4 v[28:31], v98, s[48:51], s59 offen offset:1024 sc1
    s_cmp_gt_u32 s18, 13
    s_cselect_b32 s59, s9, s7
    s_add_u32 s59, s59, 26624
    buffer_load_dwordx4 v[32:35], v98, s[48:51], s59 offen offset:0 sc1
    buffer_load_dwordx4 v[36:39], v98, s[48:51], s59 offen offset:1024 sc1
    s_cmp_gt_u32 s18, 14
    s_cselect_b32 s59, s9, s7
    s_add_u32 s59, s59, 28672
    buffer_load_dwordx4 v[40:43], v98, s[48:51], s59 offen offset:0 sc1
    buffer_load_dwordx4 v[44:47], v98, s[48:51], s59 offen offset:1024 sc1
    s_cmp_gt_u32 s18, 15
    s_cselect_b32 s59, s9, s7
    s_add_u32 s59, s59, 30720
    buffer_load_dwordx4 v[48:51], v98, s[48:51], s59 offen offset:0 sc1
    buffer_load_dwordx4 v[52:55], v98, s[48:51], s59 offen offset:1024 sc1
    v_mov_b32 v99, 0
    s_waitcnt vmcnt(0)
    v_max3_u32 v99, v99, v24, v25
    v_max3_u32 v99, v99, v26, v27
    v_max3_u32 v99, v99, v28, v29
    v_max3_u32 v99, v99, v30, v31
    v_max3_u32 v99, v99, v32, v33
    v_max3_u32 v99, v99, v34, v35
    v_max3_u32 v99, v99, v36, v37
    v_max3_u32 v99, v99, v38, v39
    v_max3_u32 v99, v99, v40, v41
    v_max3_u32 v99, v99, v42, v43
    v_max3_u32 v99, v99, v44, v45
    v_max3_u32 v99, v99, v46, v47
    v_max3_u32 v99, v99, v48, v49
    v_max3_u32 v99, v99, v50, v51
    v_max3_u32 v99, v99, v52, v53
    v_max3_u32 v99, v99, v54, v55
    v_cmp_eq_u32 vcc, -1, v99
    s_cbranch_vccz C_SL_5_OK
    s_sleep 2
    s_add_u32 s10, s10, 1
    s_cmp_lt_u32 s10, 200000
    s_cbranch_scc1 C_SL_5
C_SL_5_OK:
    v_mfma_f32_32x32x16_bf16 v[8:23], v[196:199], v[24:27], v[8:23]
    v_mfma_f32_32x32x16_bf16 v[8:23], v[200:203], v[28:31], v[8:23]
    v_mfma_f32_32x32x16_bf16 v[8:23], v[204:207], v[32:35], v[8:23]
    v_mfma_f32_32x32x16_bf16 v[8:23], v[208:211], v[36:39], v[8:23]
    v_mfma_f32_32x32x16_bf16 v[8:23], v[212:215], v[40:43], v[8:23]
    v_mfma_f32_32x32x16_bf16 v[8:23], v[216:219], v[44:47], v[8:23]
    v_mfma_f32_32x32x16_bf16 v[8:23], v[220:223], v[48:51], v[8:23]
    v_mfma_f32_32x32x16_bf16 v[8:23], v[224:227], v[52:55], v[8:23]
    s_nop 15
C_SL_6:
    s_cmp_gt_u32 s18, 16
    s_cselect_b32 s59, s9, s7
    s_add_u32 s59, s59, 32768
    buffer_load_dwordx4 v[24:27], v98, s[48:51], s59 offen offset:0 sc1
    ds_read_b64_tr_b16 v[56:57], v95 offset:0
    ds_read_b64_tr_b16 v[58:59], v95 offset:1024
    s_waitcnt lgkmcnt(0)
    buffer_load_dwordx4 v[28:31], v98, s[48:51], s59 offen offset:1024 sc1
    ds_read_b64_tr_b16 v[60:61], v95 offset:4096
    ds_read_b64_tr_b16 v[62:63], v95 offset:5120
    s_waitcnt lgkmcnt(0)
    s_cmp_gt_u32 s18, 17
    s_cselect_b32 s59, s9, s7
    s_add_u32 s59, s59, 34816
    buffer_load_dwordx4 v[32:35], v98, s[48:51], s59 offen offset:0 sc1
    ds_read_b64_tr_b16 v[64:65], v95 offset:8192
    ds_read_b64_tr_b16 v[66:67], v95 offset:9216
    s_waitcnt lgkmcnt(0)
    buffer_load_dwordx4 v[36:39], v98, s[48:51], s59 offen offset:1024 sc1
    ds_read_b64_tr_b16 v[68:69], v95 offset:12288
    ds_read_b64_tr_b16 v[70:71], v95 offset:13312
    s_waitcnt lgkmcnt(0)
    s_cmp_gt_u32 s18, 18
    s_cselect_b32 s59, s9, s7
    s_add_u32 s59, s59, 36864
    buffer_load_dwordx4 v[40:43], v98, s[48:51], s59 offen offset:0 sc1
    ds_read_b64_tr_b16 v[72:73], v95 offset:16384
    ds_read_b64_tr_b16 v[74:75], v95 offset:17408
    s_waitcnt lgkmcnt(0)
    buffer_load_dwordx4 v[44:47], v98, s[48:51], s59 offen offset:1024 sc1
    ds_read_b64_tr_b16 v[76:77], v95 offset:20480
    ds_read_b64_tr_b16 v[78:79], v95 offset:21504
    s_waitcnt lgkmcnt(0)
    s_cmp_gt_u32 s18, 19
    s_cselect_b32 s59, s9, s7
    s_add_u32 s59, s59, 38912
    buffer_load_dwordx4 v[48:51], v98, s[48:51], s59 offen offset:0 sc1
    ds_read_b64_tr_b16 v[80:81], v95 offset:24576
    ds_read_b64_tr_b16 v[82:83], v95 offset:25600
    s_waitcnt lgkmcnt(0)
    buffer_load_dwordx4 v[52:55], v98, s[48:51], s59 offen offset:1024 sc1
    ds_read_b64_tr_b16 v[84:85], v95 offset:28672
    ds_read_b64_tr_b16 v[86:87], v95 offset:29696
    s_waitcnt lgkmcnt(0)
    v_mov_b32 v99, 0
    s_waitcnt vmcnt(0)
    v_max3_u32 v99, v99, v24, v25
    v_max3_u32 v99, v99, v26, v27
    v_max3_u32 v99, v99, v28, v29
    v_max3_u32 v99, v99, v30, v31
    v_max3_u32 v99, v99, v32, v33
    v_max3_u32 v99, v99, v34, v35
    v_max3_u32 v99, v99, v36, v37
    v_max3_u32 v99, v99, v38, v39
    v_max3_u32 v99, v99, v40, v41
    v_max3_u32 v99, v99, v42, v43
    v_max3_u32 v99, v99, v44, v45
    v_max3_u32 v99, v99, v46, v47
    v_max3_u32 v99, v99, v48, v49
    v_max3_u32 v99, v99, v50, v51
    v_max3_u32 v99, v99, v52, v53
    v_max3_u32 v99, v99, v54, v55
    v_cmp_eq_u32 vcc, -1, v99
    s_cbranch_vccz C_SL_6_OK
    s_sleep 2
    s_add_u32 s10, s10, 1
    s_cmp_lt_u32 s10, 200000
    s_cbranch_scc1 C_SL_6
C_SL_6_OK:
    v_mfma_f32_32x32x16_bf16 v[8:23], v[56:59], v[24:27], v[8:23]
    v_mfma_f32_32x32x16_bf16 v[8:23], v[60:63], v[28:31], v[8:23]
    v_mfma_f32_32x32x16_bf16 v[8:23], v[64:67], v[32:35], v[8:23]
    v_mfma_f32_32x32x16_bf16 v[8:23], v[68:71], v[36:39], v[8:23]
    v_mfma_f32_32x32x16_bf16 v[8:23], v[72:75], v[40:43], v[8:23]
    v_mfma_f32_32x32x16_bf16 v[8:23], v[76:79], v[44:47], v[8:23]
    v_mfma_f32_32x32x16_bf16 v[8:23], v[80:83], v[48:51], v[8:23]
    v_mfma_f32_32x32x16_bf16 v[8:23], v[84:87], v[52:55], v[8:23]
    s_nop 15
C_SL_7:
    s_cmp_gt_u32 s18, 20
    s_cselect_b32 s59, s9, s7
    s_add_u32 s59, s59, 40960
    buffer_load_dwordx4 v[24:27], v98, s[48:51], s59 offen offset:0 sc1
    ds_read_b64_tr_b16 v[56:57], v95 offset:32768
    ds_read_b64_tr_b16 v[58:59], v95 offset:33792
    s_waitcnt lgkmcnt(0)
    buffer_load_dwordx4 v[28:31], v98, s[48:51], s59 offen offset:1024 sc1
    ds_read_b64_tr_b16 v[60:61], v95 offset:36864
    ds_read_b64_tr_b16 v[62:63], v95 offset:37888
    s_waitcnt lgkmcnt(0)
    s_cmp_gt_u32 s18, 21
    s_cselect_b32 s59, s9, s7
    s_add_u32 s59, s59, 43008
    buffer_load_dwordx4 v[32:35], v98, s[48:51], s59 offen offset:0 sc1
    ds_read_b64_tr_b16 v[64:65], v95 offset:40960
    ds_read_b64_tr_b16 v[66:67], v95 offset:41984
    s_waitcnt lgkmcnt(0)
    buffer_load_dwordx4 v[36:39], v98, s[48:51], s59 offen offset:1024 sc1
    ds_read_b64_tr_b16 v[68:69], v95 offset:45056
    ds_read_b64_tr_b16 v[70:71], v95 offset:46080
    s_waitcnt lgkmcnt(0)
    s_cmp_gt_u32 s18, 22
    s_cselect_b32 s59, s9, s7
    s_add_u32 s59, s59, 45056
    buffer_load_dwordx4 v[40:43], v5, s[48:51], s59 offen offset:0 sc1
    ds_read_b64_tr_b16 v[72:73], v95 offset:49152
    ds_read_b64_tr_b16 v[74:75], v95 offset:50176
    s_waitcnt lgkmcnt(0)
    buffer_load_dwordx4 v[44:47], v5, s[48:51], s59 offen offset:1024 sc1
    ds_read_b64_tr_b16 v[76:77], v95 offset:53248
    ds_read_b64_tr_b16 v[78:79], v95 offset:54272
    s_waitcnt lgkmcnt(0)
    v_mov_b32 v99, 0
    s_waitcnt vmcnt(0)
    v_max3_u32 v99, v99, v24, v25
    v_max3_u32 v99, v99, v26, v27
    v_max3_u32 v99, v99, v28, v29
    v_max3_u32 v99, v99, v30, v31
    v_max3_u32 v99, v99, v32, v33
    v_max3_u32 v99, v99, v34, v35
    v_max3_u32 v99, v99, v36, v37
    v_max3_u32 v99, v99, v38, v39
    v_max3_u32 v99, v99, v40, v41
    v_max3_u32 v99, v99, v42, v43
    v_max3_u32 v99, v99, v44, v45
    v_max3_u32 v99, v99, v46, v47
    v_cmp_eq_u32 vcc, -1, v99
    s_cbranch_vccz C_SL_7_OK
    s_sleep 2
    s_add_u32 s10, s10, 1
    s_cmp_lt_u32 s10, 200000
    s_cbranch_scc1 C_SL_7
C_SL_7_OK:
    v_mfma_f32_32x32x16_bf16 v[8:23], v[56:59], v[24:27], v[8:23]
    v_mfma_f32_32x32x16_bf16 v[8:23], v[60:63], v[28:31], v[8:23]
    v_mfma_f32_32x32x16_bf16 v[8:23], v[64:67], v[32:35], v[8:23]
    v_mfma_f32_32x32x16_bf16 v[8:23], v[68:71], v[36:39], v[8:23]
    v_mfma_f32_32x32x16_bf16 v[8:23], v[72:75], v[40:43], v[8:23]
    v_mfma_f32_32x32x16_bf16 v[8:23], v[76:79], v[44:47], v[8:23]
    s_nop 15
    s_branch C_OUT
.section .rodata,"a"
.p2align 6
.amdhsa_kernel standalone__weight_only_int_quip__sampling_kernel
  .amdhsa_next_free_vgpr 256
  .amdhsa_next_free_sgpr 100
  .amdhsa_accum_offset 256
  .amdhsa_group_segment_fixed_size 0
  .amdhsa_kernarg_size 72
  .amdhsa_user_sgpr_count 2
  .amdhsa_user_sgpr_kernarg_segment_ptr 1
  .amdhsa_system_sgpr_workgroup_id_x 1
.end_amdhsa_kernel
.p2align 6
tab_c:
.long 0x1, 0x15, 0x17000109, 0x2e000201, 0x2e000211, 0x44000305, 0x44000319, 0x5a00040d
.long 0x80005, 0x80019, 0x1708010d, 0x2e080205, 0x2e080215, 0x44080309, 0x5a000401, 0x5a080411
.long 0x100009, 0x17000101, 0x17100111, 0x2e100209, 0x2e100219, 0x4410030d, 0x5a080405, 0x5a100415
.long 0x2000d, 0x17080105, 0x17020115, 0x2e03020d, 0x44000301, 0x44030311, 0x5a100409, 0x5a030419
.long 0xa0011, 0x100012, 0x170a0119, 0x1700011a, 0x2e030210, 0x440b0315, 0x44080316, 0x5a0b040b
.long 0x120000, 0x20013, 0x17120108, 0x1708011b, 0x2e0b0212, 0x44130306, 0x44100317, 0x5a13040c
.long 0x40002, 0xa0014, 0x1704010a, 0x2e0b0200, 0x2e130213, 0x44060307, 0x44030318, 0x5a06040e
.long 0xc0003, 0x120016, 0x170c010b, 0x2e130202, 0x2e060214, 0x440e0308, 0x440b031a, 0x5a0e040f
.long 0x140004, 0x40017, 0x1714010c, 0x2e060203, 0x2e0e0216, 0x4400030a, 0x4413031b, 0x5a000410
.long 0x60006, 0xc0018, 0x1706010e, 0x2e0e0204, 0x2e000217, 0x4409030b, 0x5a030400, 0x5a090412
.long 0xe0007, 0x14001a, 0x170e010f, 0x2e000206, 0x2e090218, 0x4411030c, 0x5a0b0402, 0x5a110413
.long 0x160008, 0x6001b, 0x17160110, 0x2e090207, 0x2e11021a, 0x4403030e, 0x5a130403, 0x5a030414
.long 0x8000a, 0x17100100, 0x17080112, 0x2e110208, 0x2e03021b, 0x440c030f, 0x5a060404, 0x5a0c0416
.long 0x10000b, 0x17020102, 0x17100113, 0x2e03020a, 0x44080300, 0x44140310, 0x5a0e0406, 0x5a140417
.long 0x1000c, 0x170a0103, 0x17010114, 0x2e0c020b, 0x44100302, 0x44060312, 0x5a000407, 0x5a060418
.long 0xa000e, 0x17120104, 0x170a0116, 0x2e14020c, 0x44030303, 0x440f0313, 0x5a090408, 0x5a0f041a
.long 0x12000f, 0x17040106, 0x17120117, 0x2e06020e, 0x440b0304, 0x44010314, 0x5a11040a, 0x5a01041b
.long 0x30010, 0x170c0107, 0x17030118, 0x2e0f020f, 0x0, 0x0, 0x0, 0x0
.long 0xffffffff, 0xffffffff, 0xffffffff, 0xffffffff, 0xffffffff, 0xffffffff, 0xffffffff, 0xffffffff
.long 0xffffffff, 0xffffffff, 0xffffffff, 0xffffffff, 0xffffffff, 0xffffffff, 0xffffffff, 0xffffffff
.long 0xffffffff, 0xffffffff, 0xffffffff, 0xffffffff, 0xffffffff, 0xffffffff, 0xffffffff, 0xffffffff
.long 0xffffffff, 0xffffffff, 0xffffffff, 0xffffffff, 0xffffffff, 0xffffffff, 0xffffffff, 0xffffffff
.long 0xffffffff, 0xffffffff, 0xffffffff, 0xffffffff, 0xffffffff, 0xffffffff, 0xffffffff, 0xffffffff
.long 0xffffffff, 0xffffffff, 0xffffffff, 0xffffffff, 0xffffffff, 0xffffffff, 0xffffffff, 0xffffffff
.long 0xffffffff, 0xffffffff, 0xffffffff, 0xffffffff, 0xffffffff, 0xffffffff, 0xffffffff, 0xffffffff
.long 0xffffffff, 0xffffffff, 0xffffffff, 0xffffffff, 0xffffffff, 0xffffffff, 0xffffffff, 0xffffffff
.long 0xffffffff, 0xffffffff, 0xffffffff, 0xffffffff, 0xffffffff, 0xffffffff, 0xffffffff, 0xffffffff
.long 0xffffffff, 0xffffffff, 0xffffffff, 0xffffffff, 0xffffffff, 0xffffffff, 0xffffffff, 0xffffffff
.long 0xffffffff, 0xffffffff, 0xffffffff, 0xffffffff, 0xffffffff, 0xffffffff, 0xffffffff, 0xffffffff
.long 0xffffffff, 0xffffffff, 0xffffffff, 0xffffffff, 0xffffffff, 0xffffffff, 0xffffffff, 0xffffffff
.long 0xffffffff, 0xffffffff, 0xffffffff, 0xffffffff, 0xffffffff, 0xffffffff, 0xffffffff, 0xffffffff
.long 0xffffffff, 0xffffffff, 0xffffffff, 0xffffffff, 0xffffffff, 0xffffffff, 0xffffffff, 0xffffffff
.long 0xffffffff, 0xffffffff, 0xffffffff, 0xffffffff, 0xffffffff, 0xffffffff, 0xffffffff, 0xffffffff
.long 0xffffffff, 0xffffffff, 0xffffffff, 0xffffffff, 0xffffffff, 0xffffffff, 0xffffffff, 0xffffffff
.long 0xffffffff, 0xffffffff, 0xffffffff, 0xffffffff, 0xffffffff, 0xffffffff, 0xffffffff, 0xffffffff
.long 0xffffffff, 0xffffffff, 0xffffffff, 0xffffffff, 0xffffffff, 0xffffffff, 0xffffffff, 0xffffffff
.long 0xffffffff, 0xffffffff, 0xffffffff, 0xffffffff, 0xffffffff, 0xffffffff, 0xffffffff, 0xffffffff
.long 0xffffffff, 0xffffffff, 0xffffffff, 0xffffffff, 0xffffffff, 0xffffffff, 0xffffffff, 0xffffffff
.long 0xffffffff, 0xffffffff, 0xffffffff, 0xffffffff, 0xffffffff, 0xffffffff, 0xffffffff, 0xffffffff
.long 0xffffffff, 0xffffffff, 0xffffffff, 0xffffffff, 0xffffffff, 0xffffffff, 0xffffffff, 0xffffffff
.long 0xffffffff, 0xffffffff, 0xffffffff, 0xffffffff, 0xffffffff, 0xffffffff, 0xffffffff, 0xffffffff
.long 0xffffffff, 0xffffffff, 0xffffffff, 0xffffffff, 0xffffffff, 0xffffffff, 0xffffffff, 0xffffffff
.long 0xffffffff, 0xffffffff, 0xffffffff, 0xffffffff, 0xffffffff, 0xffffffff, 0xffffffff, 0xffffffff
.long 0xffffffff, 0xffffffff, 0xffffffff, 0xffffffff, 0xffffffff, 0xffffffff, 0xffffffff, 0xffffffff
.long 0xffffffff, 0xffffffff, 0xffffffff, 0xffffffff, 0xffffffff, 0xffffffff, 0xffffffff, 0xffffffff
.long 0xffffffff, 0xffffffff, 0xffffffff, 0xffffffff, 0xffffffff, 0xffffffff, 0xffffffff, 0xffffffff
.long 0xffffffff, 0xffffffff, 0xffffffff, 0xffffffff, 0xffffffff, 0xffffffff, 0xffffffff, 0xffffffff
.long 0xffffffff, 0xffffffff, 0xffffffff, 0xffffffff, 0xffffffff, 0xffffffff, 0xffffffff, 0xffffffff
.long 0xffffffff, 0xffffffff, 0xffffffff, 0xffffffff, 0xffffffff, 0xffffffff, 0xffffffff, 0xffffffff
.long 0xffffffff, 0xffffffff, 0xffffffff, 0xffffffff, 0xffffffff, 0xffffffff, 0xffffffff, 0xffffffff
.long 0xffffffff, 0xffffffff, 0xffffffff, 0xffffffff, 0xffffffff, 0xffffffff, 0xffffffff, 0xffffffff
.long 0xffffffff, 0xffffffff, 0xffffffff, 0xffffffff, 0xffffffff, 0xffffffff, 0xffffffff, 0xffffffff
.long 0xffffffff, 0xffffffff, 0xffffffff, 0xffffffff, 0xffffffff, 0xffffffff, 0xffffffff, 0xffffffff
.long 0xffffffff, 0xffffffff, 0xffffffff, 0xffffffff, 0xffffffff, 0xffffffff, 0xffffffff, 0xffffffff
.long 0xffffffff, 0xffffffff, 0xffffffff, 0xffffffff, 0xffffffff, 0xffffffff, 0xffffffff, 0xffffffff
.long 0xffffffff, 0xffffffff, 0xffffffff, 0xffffffff, 0xffffffff, 0xffffffff, 0xffffffff, 0xffffffff
.long 0xffffffff, 0xffffffff, 0xffffffff, 0xffffffff, 0xffffffff, 0xffffffff, 0xffffffff, 0xffffffff
.long 0xffffffff, 0xffffffff, 0xffffffff, 0xffffffff, 0xffffffff, 0xffffffff, 0xffffffff, 0xffffffff
.long 0xffffffff, 0xffffffff, 0xffffffff, 0xffffffff, 0xffffffff, 0xffffffff, 0xffffffff, 0xffffffff
.long 0xffffffff, 0xffffffff, 0xffffffff, 0xffffffff, 0xffffffff, 0xffffffff, 0xffffffff, 0xffffffff
.long 0xffffffff, 0xffffffff, 0xffffffff, 0xffffffff, 0xffffffff, 0xffffffff, 0xffffffff, 0xffffffff
.long 0xffffffff, 0xffffffff, 0xffffffff, 0xffffffff, 0xffffffff, 0xffffffff, 0xffffffff, 0xffffffff
.long 0xffffffff, 0xffffffff, 0xffffffff, 0xffffffff, 0xffffffff, 0xffffffff, 0xffffffff, 0xffffffff
.long 0xffffffff, 0xffffffff, 0xffffffff, 0xffffffff, 0xffffffff, 0xffffffff, 0xffffffff, 0xffffffff
.long 0xffffffff, 0xffffffff, 0xffffffff, 0xffffffff, 0xffffffff, 0xffffffff, 0xffffffff, 0xffffffff
.long 0xffffffff, 0xffffffff, 0xffffffff, 0xffffffff, 0xffffffff, 0xffffffff, 0xffffffff, 0xffffffff
.long 0xffffffff, 0xffffffff, 0xffffffff, 0xffffffff, 0xffffffff, 0xffffffff, 0xffffffff, 0xffffffff
.long 0xffffffff, 0xffffffff, 0xffffffff, 0xffffffff, 0xffffffff, 0xffffffff, 0xffffffff, 0xffffffff
.long 0xffffffff, 0xffffffff, 0xffffffff, 0xffffffff, 0xffffffff, 0xffffffff, 0xffffffff, 0xffffffff
.long 0xffffffff, 0xffffffff, 0xffffffff, 0xffffffff, 0xffffffff, 0xffffffff, 0xffffffff, 0xffffffff
.long 0xffffffff, 0xffffffff, 0xffffffff, 0xffffffff, 0xffffffff, 0xffffffff, 0xffffffff, 0xffffffff
.long 0xffffffff, 0xffffffff, 0xffffffff, 0xffffffff, 0xffffffff, 0xffffffff, 0xffffffff, 0xffffffff
.long 0xffffffff, 0xffffffff, 0xffffffff, 0xffffffff, 0xffffffff, 0xffffffff, 0xffffffff, 0xffffffff
.long 0xffffffff, 0xffffffff, 0xffffffff, 0xffffffff, 0xffffffff, 0xffffffff, 0xffffffff, 0xffffffff
.long 0xffffffff, 0xffffffff, 0xffffffff, 0xffffffff, 0xffffffff, 0xffffffff, 0xffffffff, 0xffffffff
.long 0xffffffff, 0xffffffff, 0xffffffff, 0xffffffff, 0xffffffff, 0xffffffff, 0xffffffff, 0xffffffff
.long 0xffffffff, 0xffffffff, 0xffffffff, 0xffffffff, 0xffffffff, 0xffffffff, 0xffffffff, 0xffffffff
.long 0xffffffff, 0xffffffff, 0xffffffff, 0xffffffff, 0xffffffff, 0xffffffff, 0xffffffff, 0xffffffff
.long 0xffffffff, 0xffffffff, 0xffffffff, 0xffffffff, 0xffffffff, 0xffffffff, 0xffffffff, 0xffffffff
.long 0xffffffff, 0xffffffff, 0xffffffff, 0xffffffff, 0xffffffff, 0xffffffff, 0xffffffff, 0xffffffff
.long 0xffffffff, 0xffffffff, 0xffffffff, 0xffffffff, 0xffffffff, 0xffffffff, 0xffffffff, 0xffffffff
.long 0xffffffff, 0xffffffff, 0xffffffff, 0xffffffff, 0xffffffff, 0xffffffff, 0xffffffff, 0xffffffff
.long 0xffffffff, 0xffffffff, 0xffffffff, 0xffffffff, 0xffffffff, 0xffffffff, 0xffffffff, 0xffffffff
.long 0xffffffff, 0xffffffff, 0xffffffff, 0xffffffff, 0xffffffff, 0xffffffff, 0xffffffff, 0xffffffff
.long 0xee700, 0xffffffff, 0xb6e700, 0xffffffff, 0xb75700, 0xffffffff, 0x7f1f00, 0xffffffff
.long 0xffffffff, 0xffffffff, 0xffffffff, 0x1c1580, 0xffffffff, 0xffffffff, 0xffffffff, 0xffffffff
.long 0xffffffff, 0xffffffff, 0xffffffff, 0xffffffff, 0xffffffff, 0xffffffff, 0xffffffff, 0xffffffff
.long 0xffffffff, 0xffffffff, 0xffffffff, 0xffffffff, 0xffffffff, 0xffffffff, 0xffffffff, 0xffffffff
.long 0xef500, 0xffffffff, 0xb6f500, 0xffffffff, 0xb76500, 0xffffffff, 0x7f2d00, 0xffffffff
.long 0xffffffff, 0xffffffff, 0xffffffff, 0xbd0180, 0xffffffff, 0xffffffff, 0xffffffff, 0xffffffff
.long 0xefc00, 0xffffffff, 0xb6fc00, 0xffffffff, 0xf3400, 0xffffffff, 0xb73400, 0xffffffff
.long 0xffffffff, 0xffffffff, 0xffffffff, 0xbd1180, 0xffffffff, 0xffffffff, 0xffffffff, 0xffffffff
.long 0xffffffff, 0xffffffff, 0xffffffff, 0xffffffff, 0xffffffff, 0xffffffff, 0xffffffff, 0xffffffff
.long 0xffffffff, 0xffffffff, 0xffffffff, 0xffffffff, 0xffffffff, 0xffffffff, 0xffffffff, 0xffffffff
.long 0xf0a00, 0xffffffff, 0xb70a00, 0xffffffff, 0x9b4200, 0xffffffff, 0xffffffff, 0xffffffff
.long 0xffffffff, 0xffffffff, 0xffffffff, 0x10a1980, 0xffffffff, 0xffffffff, 0xffffffff, 0xffffffff
.long 0xf1100, 0xffffffff, 0xb71100, 0xffffffff, 0xf4900, 0xffffffff, 0xb74900, 0xffffffff
.long 0xffffffff, 0xffffffff, 0xffffffff, 0x1570d80, 0xffffffff, 0xffffffff, 0xffffffff, 0xffffffff
.long 0xee000, 0xffffffff, 0xa1e000, 0xffffffff, 0x9b5000, 0xffffffff, 0x4e1800, 0xffffffff
.long 0xffffffff, 0xffffffff, 0xffffffff, 0x1c0180, 0xffffffff, 0xffffffff, 0xffffffff, 0xffffffff
.long 0x15e700, 0xffffffff, 0xbde700, 0xffffffff, 0xbe5700, 0xffffffff, 0x861f00, 0xffffffff
.long 0xffffffff, 0xffffffff, 0xffffffff, 0x381980, 0xffffffff, 0xffffffff, 0xffffffff, 0xffffffff
.long 0xeee00, 0xffffffff, 0xa1ee00, 0xffffffff, 0x472600, 0xffffffff, 0xda2600, 0xffffffff
.long 0xffffffff, 0xffffffff, 0xffffffff, 0x6c8980, 0xffffffff, 0xffffffff, 0xffffffff, 0xffffffff
.long 0x15f500, 0xffffffff, 0xbdf500, 0xffffffff, 0xbe6500, 0xffffffff, 0x862d00, 0xffffffff
.long 0xffffffff, 0xffffffff, 0xffffffff, 0xd90580, 0xffffffff, 0xffffffff, 0xffffffff, 0xffffffff
.long 0x15fc00, 0xffffffff, 0xbdfc00, 0xffffffff, 0x163400, 0xffffffff, 0xbe3400, 0xffffffff
.long 0xffffffff, 0xffffffff, 0xffffffff, 0xd91580, 0xffffffff, 0xffffffff, 0xffffffff, 0xffffffff
.long 0xf0300, 0xffffffff, 0xa20300, 0xffffffff, 0xd37300, 0xffffffff, 0x863b00, 0xffffffff
.long 0xffffffff, 0xffffffff, 0xffffffff, 0x10a0580, 0xffffffff, 0xffffffff, 0xffffffff, 0xffffffff
.long 0x160a00, 0xffffffff, 0xbe0a00, 0xffffffff, 0xa24200, 0xffffffff, 0xffffffff, 0xffffffff
.long 0xffffffff, 0xffffffff, 0xffffffff, 0x1570180, 0xffffffff, 0xffffffff, 0xffffffff, 0xffffffff
.long 0x161100, 0xffffffff, 0xbe1100, 0xffffffff, 0x164900, 0xffffffff, 0xbe4900, 0xffffffff
.long 0xffffffff, 0xffffffff, 0xffffffff, 0x1731180, 0xffffffff, 0xffffffff, 0xffffffff, 0xffffffff
.long 0x15e000, 0xffffffff, 0xb6e000, 0xffffffff, 0xa25000, 0xffffffff, 0x631800, 0xffffffff
.long 0xffffffff, 0xffffffff, 0xffffffff, 0x380580, 0xffffffff, 0xffffffff, 0xffffffff, 0xffffffff
.long 0x2ae700, 0xffffffff, 0xd2e700, 0xffffffff, 0xd35700, 0xffffffff, 0x9b1f00, 0xffffffff
.long 0xffffffff, 0xffffffff, 0xffffffff, 0x6c8180, 0xffffffff, 0xffffffff, 0xffffffff, 0xffffffff
.long 0x15ee00, 0xffffffff, 0xb6ee00, 0xffffffff, 0x4e2600, 0xffffffff, 0xffffffff, 0xffffffff
.long 0xffffffff, 0xffffffff, 0xffffffff, 0x888d80, 0xffffffff, 0xffffffff, 0xffffffff, 0xffffffff
.long 0x2af500, 0xffffffff, 0xd2f500, 0xffffffff, 0xd36500, 0xffffffff, 0x9b2d00, 0xffffffff
.long 0xffffffff, 0xffffffff, 0xffffffff, 0xa80980, 0xffffffff, 0xffffffff, 0xffffffff, 0xffffffff
.long 0x2afc00, 0xffffffff, 0xd2fc00, 0xffffffff, 0x2b3400, 0xffffffff, 0xd33400, 0xffffffff
.long 0xffffffff, 0xffffffff, 0xffffffff, 0xa81980, 0xffffffff, 0xffffffff, 0xffffffff, 0xffffffff
.long 0x160300, 0xffffffff, 0xb70300, 0xffffffff, 0xda7300, 0xffffffff, 0x9b3b00, 0xffffffff
.long 0xffffffff, 0xffffffff, 0xffffffff, 0x1260980, 0xffffffff, 0xffffffff, 0xffffffff, 0xffffffff
.long 0x2b0a00, 0xffffffff, 0xd30a00, 0xffffffff, 0xb74200, 0xffffffff, 0xffffffff, 0xffffffff
.long 0xffffffff, 0xffffffff, 0xffffffff, 0x1730580, 0xffffffff, 0xffffffff, 0xffffffff, 0xffffffff
.long 0x2b1100, 0xffffffff, 0xd31100, 0xffffffff, 0x2b4900, 0xffffffff, 0xd34900, 0xffffffff
.long 0xffffffff, 0xffffffff, 0xffffffff, 0x1421580, 0xffffffff, 0xffffffff, 0xffffffff, 0xffffffff
.long 0x2ae000, 0xffffffff, 0xbde000, 0xffffffff, 0xb75000, 0xffffffff, 0x6a1800, 0xffffffff
.long 0xffffffff, 0xffffffff, 0xffffffff, 0x38980, 0xffffffff, 0xffffffff, 0xffffffff, 0xffffffff
.long 0x31e700, 0xffffffff, 0xd9e700, 0xffffffff, 0xda5700, 0xffffffff, 0xa21f00, 0xffffffff
.long 0xffffffff, 0xffffffff, 0xffffffff, 0x888580, 0xffffffff, 0xffffffff, 0xffffffff, 0xffffffff
.long 0x2aee00, 0xffffffff, 0xbdee00, 0xffffffff, 0x632600, 0xffffffff, 0xffffffff, 0xffffffff
.long 0xffffffff, 0xffffffff, 0xffffffff, 0x541180, 0xffffffff, 0xffffffff, 0xffffffff, 0xffffffff
.long 0x31f500, 0xffffffff, 0xd9f500, 0xffffffff, 0xda6500, 0xffffffff, 0xa22d00, 0xffffffff
.long 0xffffffff, 0xffffffff, 0xffffffff, 0xc78d80, 0xffffffff, 0xffffffff, 0xffffffff, 0xffffffff
.long 0x31fc00, 0xffffffff, 0xd9fc00, 0xffffffff, 0x323400, 0xffffffff, 0xda3400, 0xffffffff
.long 0xffffffff, 0xffffffff, 0xffffffff, 0x10a0180, 0xffffffff, 0xffffffff, 0xffffffff, 0xffffffff
.long 0x2b0300, 0xffffffff, 0xbe0300, 0xffffffff, 0xf3b00, 0xffffffff, 0xa23b00, 0xffffffff
.long 0xffffffff, 0xffffffff, 0xffffffff, 0xf50d80, 0xffffffff, 0xffffffff, 0xffffffff, 0xffffffff
.long 0x320a00, 0xffffffff, 0xda0a00, 0xffffffff, 0xbe4200, 0xffffffff, 0xffffffff, 0xffffffff
.long 0xffffffff, 0xffffffff, 0xffffffff, 0x1420980, 0xffffffff, 0xffffffff, 0xffffffff, 0xffffffff
.long 0x321100, 0xffffffff, 0xda1100, 0xffffffff, 0x324900, 0xffffffff, 0xda4900, 0xffffffff
.long 0xffffffff, 0xffffffff, 0xffffffff, 0x1619980, 0xffffffff, 0xffffffff, 0xffffffff, 0xffffffff
.long 0x31e000, 0xffffffff, 0xd2e000, 0xffffffff, 0xbe5000, 0xffffffff, 0x7f1800, 0xffffffff
.long 0xffffffff, 0xffffffff, 0xffffffff, 0x230d80, 0xffffffff, 0xffffffff, 0xffffffff, 0xffffffff
.long 0x46e700, 0xffffffff, 0x475700, 0xffffffff, 0xf1f00, 0xffffffff, 0xb71f00, 0xffffffff
.long 0xffffffff, 0xffffffff, 0xffffffff, 0x231580, 0xffffffff, 0xffffffff, 0xffffffff, 0xffffffff
.long 0x31ee00, 0xffffffff, 0xd2ee00, 0xffffffff, 0x6a2600, 0xffffffff, 0xffffffff, 0xffffffff
.long 0xffffffff, 0xffffffff, 0xffffffff, 0x739580, 0xffffffff, 0xffffffff, 0xffffffff, 0xffffffff
.long 0x46f500, 0xffffffff, 0x476500, 0xffffffff, 0xf2d00, 0xffffffff, 0xb72d00, 0xffffffff
.long 0xffffffff, 0xffffffff, 0xffffffff, 0xc40180, 0xffffffff, 0xffffffff, 0xffffffff, 0xffffffff
.long 0x46fc00, 0xffffffff, 0x7f6c00, 0xffffffff, 0x473400, 0xffffffff, 0xffffffff, 0xffffffff
.long 0xffffffff, 0xffffffff, 0xffffffff, 0xc41180, 0xffffffff, 0xffffffff, 0xffffffff, 0xffffffff
.long 0x320300, 0xffffffff, 0xd30300, 0xffffffff, 0x163b00, 0xffffffff, 0xb73b00, 0xffffffff
.long 0xffffffff, 0xffffffff, 0xffffffff, 0x1149180, 0xffffffff, 0xffffffff, 0xffffffff, 0xffffffff
.long 0x470a00, 0xffffffff, 0x2b4200, 0xffffffff, 0xd34200, 0xffffffff, 0xffffffff, 0xffffffff
.long 0xffffffff, 0xffffffff, 0xffffffff, 0x1111980, 0xffffffff, 0xffffffff, 0xffffffff, 0xffffffff
.long 0x471100, 0xffffffff, 0x7f8100, 0xffffffff, 0x474900, 0xffffffff, 0xffffffff, 0xffffffff
.long 0xffffffff, 0xffffffff, 0xffffffff, 0x15e0d80, 0xffffffff, 0xffffffff, 0xffffffff, 0xffffffff
.long 0x46e000, 0xffffffff, 0xd9e000, 0xffffffff, 0xd35000, 0xffffffff, 0x861800, 0xffffffff
.long 0xffffffff, 0xffffffff, 0xffffffff, 0x3f1180, 0xffffffff, 0xffffffff, 0xffffffff, 0xffffffff
.long 0x4de700, 0xffffffff, 0x4e5700, 0xffffffff, 0x161f00, 0xffffffff, 0xbe1f00, 0xffffffff
.long 0xffffffff, 0xffffffff, 0xffffffff, 0x3f1980, 0xffffffff, 0xffffffff, 0xffffffff, 0xffffffff
.long 0x46ee00, 0xffffffff, 0xd9ee00, 0xffffffff, 0x7f2600, 0xffffffff, 0xffffffff, 0xffffffff
.long 0xffffffff, 0xffffffff, 0xffffffff, 0x8f9980, 0xffffffff, 0xffffffff, 0xffffffff, 0xffffffff
.long 0x4df500, 0xffffffff, 0x4e6500, 0xffffffff, 0x162d00, 0xffffffff, 0xbe2d00, 0xffffffff
.long 0xffffffff, 0xffffffff, 0xffffffff, 0xe00580, 0xffffffff, 0xffffffff, 0xffffffff, 0xffffffff
.long 0x4dfc00, 0xffffffff, 0x866c00, 0xffffffff, 0x4e3400, 0xffffffff, 0xffffffff, 0xffffffff
.long 0xffffffff, 0xffffffff, 0xffffffff, 0xe01580, 0xffffffff, 0xffffffff, 0xffffffff, 0xffffffff
.long 0x470300, 0xffffffff, 0xda0300, 0xffffffff, 0x2b3b00, 0xffffffff, 0xbe3b00, 0xffffffff
.long 0xffffffff, 0xffffffff, 0xffffffff, 0x1309580, 0xffffffff, 0xffffffff, 0xffffffff, 0xffffffff
.long 0x4e0a00, 0xffffffff, 0x324200, 0xffffffff, 0xda4200, 0xffffffff, 0xffffffff, 0xffffffff
.long 0xffffffff, 0xffffffff, 0xffffffff, 0x15e0180, 0xffffffff, 0xffffffff, 0xffffffff, 0xffffffff
.long 0x4e1100, 0xffffffff, 0x868100, 0xffffffff, 0x4e4900, 0xffffffff, 0xffffffff, 0xffffffff
.long 0xffffffff, 0xffffffff, 0xffffffff, 0x17a1180, 0xffffffff, 0xffffffff, 0xffffffff, 0xffffffff
.long 0x4de000, 0xffffffff, 0x475000, 0xffffffff, 0xda5000, 0xffffffff, 0x9b1800, 0xffffffff
.long 0xffffffff, 0xffffffff, 0xffffffff, 0x230180, 0xffffffff, 0xffffffff, 0xffffffff, 0xffffffff
.long 0x62e700, 0xffffffff, 0x635700, 0xffffffff, 0x2b1f00, 0xffffffff, 0xd31f00, 0xffffffff
.long 0xffffffff, 0xffffffff, 0xffffffff, 0x738180, 0xffffffff, 0xffffffff, 0xffffffff, 0xffffffff
.long 0x4dee00, 0xffffffff, 0xd35e00, 0xffffffff, 0x862600, 0xffffffff, 0xffffffff, 0xffffffff
.long 0xffffffff, 0xffffffff, 0xffffffff, 0x738980, 0xffffffff, 0xffffffff, 0xffffffff, 0xffffffff
.long 0x62f500, 0xffffffff, 0x636500, 0xffffffff, 0x2b2d00, 0xffffffff, 0xd32d00, 0xffffffff
.long 0xffffffff, 0xffffffff, 0xffffffff, 0xaf0980, 0xffffffff, 0xffffffff, 0xffffffff, 0xffffffff
.long 0x62fc00, 0xffffffff, 0x9b6c00, 0xffffffff, 0x633400, 0xffffffff, 0xffffffff, 0xffffffff
.long 0xffffffff, 0xffffffff, 0xffffffff, 0xaf1980, 0xffffffff, 0xffffffff, 0xffffffff, 0xffffffff
.long 0x4e0300, 0xffffffff, 0x7f7300, 0xffffffff, 0x323b00, 0xffffffff, 0xd33b00, 0xffffffff
.long 0xffffffff, 0xffffffff, 0xffffffff, 0x1110580, 0xffffffff, 0xffffffff, 0xffffffff, 0xffffffff
.long 0x630a00, 0xffffffff, 0x474200, 0xffffffff, 0xffffffff, 0xffffffff, 0xffffffff, 0xffffffff
.long 0xffffffff, 0xffffffff, 0xffffffff, 0x17a0580, 0xffffffff, 0xffffffff, 0xffffffff, 0xffffffff
.long 0x631100, 0xffffffff, 0x9b8100, 0xffffffff, 0x634900, 0xffffffff, 0xffffffff, 0xffffffff
.long 0xffffffff, 0xffffffff, 0xffffffff, 0x1491580, 0xffffffff, 0xffffffff, 0xffffffff, 0xffffffff
.long 0x62e000, 0xffffffff, 0x4e5000, 0xffffffff, 0xf1800, 0xffffffff, 0xa21800, 0xffffffff
.long 0xffffffff, 0xffffffff, 0xffffffff, 0x3f0580, 0xffffffff, 0xffffffff, 0xffffffff, 0xffffffff
.long 0x69e700, 0xffffffff, 0x6a5700, 0xffffffff, 0x321f00, 0xffffffff, 0xda1f00, 0xffffffff
.long 0xffffffff, 0xffffffff, 0xffffffff, 0x8f8580, 0xffffffff, 0xffffffff, 0xffffffff, 0xffffffff
.long 0x62ee00, 0xffffffff, 0xda5e00, 0xffffffff, 0x9b2600, 0xffffffff, 0xffffffff, 0xffffffff
.long 0xffffffff, 0xffffffff, 0xffffffff, 0x8f8d80, 0xffffffff, 0xffffffff, 0xffffffff, 0xffffffff
.long 0x69f500, 0xffffffff, 0x6a6500, 0xffffffff, 0x322d00, 0xffffffff, 0xda2d00, 0xffffffff
.long 0xffffffff, 0xffffffff, 0xffffffff, 0xce8d80, 0xffffffff, 0xffffffff, 0xffffffff, 0xffffffff
.long 0x69fc00, 0xffffffff, 0xa26c00, 0xffffffff, 0x6a3400, 0xffffffff, 0xffffffff, 0xffffffff
.long 0xffffffff, 0xffffffff, 0xffffffff, 0x1110180, 0xffffffff, 0xffffffff, 0xffffffff, 0xffffffff
.long 0x630300, 0xffffffff, 0x867300, 0xffffffff, 0x473b00, 0xffffffff, 0xda3b00, 0xffffffff
.long 0xffffffff, 0xffffffff, 0xffffffff, 0x12d0980, 0xffffffff, 0xffffffff, 0xffffffff, 0xffffffff
.long 0x6a0a00, 0xffffffff, 0x4e4200, 0xffffffff, 0xffffffff, 0xffffffff, 0xffffffff, 0xffffffff
.long 0xffffffff, 0xffffffff, 0xffffffff, 0x1490980, 0xffffffff, 0xffffffff, 0xffffffff, 0xffffffff
.long 0x6a1100, 0xffffffff, 0xa28100, 0xffffffff, 0x6a4900, 0xffffffff, 0xffffffff, 0xffffffff
.long 0xffffffff, 0xffffffff, 0xffffffff, 0x1689980, 0xffffffff, 0xffffffff, 0xffffffff, 0xffffffff
.long 0x69e000, 0xffffffff, 0x635000, 0xffffffff, 0x161800, 0xffffffff, 0xb71800, 0xffffffff
.long 0xffffffff, 0xffffffff, 0xffffffff, 0xa8980, 0xffffffff, 0xffffffff, 0xffffffff, 0xffffffff
.long 0x7ee700, 0xffffffff, 0x7f5700, 0xffffffff, 0x471f00, 0xffffffff, 0xffffffff, 0xffffffff
.long 0xffffffff, 0xffffffff, 0xffffffff, 0xffffffff, 0xffffffff, 0xffffffff, 0xffffffff, 0xffffffff
.long 0x69ee00, 0xffffffff, 0xf2600, 0xffffffff, 0xa22600, 0xffffffff, 0xffffffff, 0xffffffff
.long 0xffffffff, 0xffffffff, 0xffffffff, 0x5b1180, 0xffffffff, 0xffffffff, 0xffffffff, 0xffffffff
.long 0x7ef500, 0xffffffff, 0x7f6500, 0xffffffff, 0x472d00, 0xffffffff, 0xffffffff, 0xffffffff
.long 0xffffffff, 0xffffffff, 0xffffffff, 0xffffffff, 0xffffffff, 0xffffffff, 0xffffffff, 0xffffffff
.long 0x7efc00, 0xffffffff, 0xb76c00, 0xffffffff, 0x7f3400, 0xffffffff, 0xffffffff, 0xffffffff
.long 0xffffffff, 0xffffffff, 0xffffffff, 0xffffffff, 0xffffffff, 0xffffffff, 0xffffffff, 0xffffffff
.long 0x6a0300, 0xffffffff, 0x9b7300, 0xffffffff, 0x4e3b00, 0xffffffff, 0xffffffff, 0xffffffff
.long 0xffffffff, 0xffffffff, 0xffffffff, 0xfc0d80, 0xffffffff, 0xffffffff, 0xffffffff, 0xffffffff
.long 0x7f0a00, 0xffffffff, 0x634200, 0xffffffff, 0xffffffff, 0xffffffff, 0xffffffff, 0xffffffff
.long 0xffffffff, 0xffffffff, 0xffffffff, 0xffffffff, 0xffffffff, 0xffffffff, 0xffffffff, 0xffffffff
.long 0x7f1100, 0xffffffff, 0xb78100, 0xffffffff, 0x7f4900, 0xffffffff, 0xffffffff, 0xffffffff
.long 0xffffffff, 0xffffffff, 0xffffffff, 0xffffffff, 0xffffffff, 0xffffffff, 0xffffffff, 0xffffffff
.long 0x7ee000, 0xffffffff, 0x6a5000, 0xffffffff, 0x2b1800, 0xffffffff, 0xbe1800, 0xffffffff
.long 0xffffffff, 0xffffffff, 0xffffffff, 0x2a0d80, 0xffffffff, 0xffffffff, 0xffffffff, 0xffffffff
.long 0x85e700, 0xffffffff, 0x865700, 0xffffffff, 0x4e1f00, 0xffffffff, 0xffffffff, 0xffffffff
.long 0xffffffff, 0xffffffff, 0xffffffff, 0xffffffff, 0xffffffff, 0xffffffff, 0xffffffff, 0xffffffff
.long 0x7eee00, 0xffffffff, 0x162600, 0xffffffff, 0xb72600, 0xffffffff, 0xffffffff, 0xffffffff
.long 0xffffffff, 0xffffffff, 0xffffffff, 0x7a9580, 0xffffffff, 0xffffffff, 0xffffffff, 0xffffffff
.long 0x85f500, 0xffffffff, 0x866500, 0xffffffff, 0x4e2d00, 0xffffffff, 0xffffffff, 0xffffffff
.long 0xffffffff, 0xffffffff, 0xffffffff, 0xffffffff, 0xffffffff, 0xffffffff, 0xffffffff, 0xffffffff
.long 0x85fc00, 0xffffffff, 0xbe6c00, 0xffffffff, 0x863400, 0xffffffff, 0xffffffff, 0xffffffff
.long 0xffffffff, 0xffffffff, 0xffffffff, 0xffffffff, 0xffffffff, 0xffffffff, 0xffffffff, 0xffffffff
.long 0x7f0300, 0xffffffff, 0xa27300, 0xffffffff, 0x633b00, 0xffffffff, 0xffffffff, 0xffffffff
.long 0xffffffff, 0xffffffff, 0xffffffff, 0x11b9180, 0xffffffff, 0xffffffff, 0xffffffff, 0xffffffff
.long 0x860a00, 0xffffffff, 0x6a4200, 0xffffffff, 0xffffffff, 0xffffffff, 0xffffffff, 0xffffffff
.long 0xffffffff, 0xffffffff, 0xffffffff, 0xffffffff, 0xffffffff, 0xffffffff, 0xffffffff, 0xffffffff
.long 0x861100, 0xffffffff, 0xbe8100, 0xffffffff, 0x864900, 0xffffffff, 0xffffffff, 0xffffffff
.long 0xffffffff, 0xffffffff, 0xffffffff, 0xffffffff, 0xffffffff, 0xffffffff, 0xffffffff, 0xffffffff
.long 0x85e000, 0xffffffff, 0x7f5000, 0xffffffff, 0x321800, 0xffffffff, 0xd31800, 0xffffffff
.long 0xffffffff, 0xffffffff, 0xffffffff, 0x461180, 0xffffffff, 0xffffffff, 0xffffffff, 0xffffffff
.long 0x9ae700, 0xffffffff, 0x9b5700, 0xffffffff, 0x631f00, 0xffffffff, 0xffffffff, 0xffffffff
.long 0xffffffff, 0xffffffff, 0xffffffff, 0xffffffff, 0xffffffff, 0xffffffff, 0xffffffff, 0xffffffff
.long 0x85ee00, 0xffffffff, 0x2b2600, 0xffffffff, 0xbe2600, 0xffffffff, 0xffffffff, 0xffffffff
.long 0xffffffff, 0xffffffff, 0xffffffff, 0x969980, 0xffffffff, 0xffffffff, 0xffffffff, 0xffffffff
.long 0x9af500, 0xffffffff, 0x9b6500, 0xffffffff, 0x632d00, 0xffffffff, 0xffffffff, 0xffffffff
.long 0xffffffff, 0xffffffff, 0xffffffff, 0xffffffff, 0xffffffff, 0xffffffff, 0xffffffff, 0xffffffff
.long 0x9afc00, 0xffffffff, 0xd36c00, 0xffffffff, 0x9b3400, 0xffffffff, 0xffffffff, 0xffffffff
.long 0xffffffff, 0xffffffff, 0xffffffff, 0xffffffff, 0xffffffff, 0xffffffff, 0xffffffff, 0xffffffff
.long 0x860300, 0xffffffff, 0xb77300, 0xffffffff, 0x6a3b00, 0xffffffff, 0xffffffff, 0xffffffff
.long 0xffffffff, 0xffffffff, 0xffffffff, 0x1379580, 0xffffffff, 0xffffffff, 0xffffffff, 0xffffffff
.long 0x9b0a00, 0xffffffff, 0x7f4200, 0xffffffff, 0xffffffff, 0xffffffff, 0xffffffff, 0xffffffff
.long 0xffffffff, 0xffffffff, 0xffffffff, 0xffffffff, 0xffffffff, 0xffffffff, 0xffffffff, 0xffffffff
.long 0x9b1100, 0xffffffff, 0xd38100, 0xffffffff, 0x9b4900, 0xffffffff, 0xffffffff, 0xffffffff
.long 0xffffffff, 0xffffffff, 0xffffffff, 0xffffffff, 0xffffffff, 0xffffffff, 0xffffffff, 0xffffffff
.long 0x9ae000, 0xffffffff, 0x865000, 0xffffffff, 0x471800, 0xffffffff, 0xda1800, 0xffffffff
.long 0xffffffff, 0xffffffff, 0xffffffff, 0xffffffff, 0xffffffff, 0xffffffff, 0xffffffff, 0xffffffff
.long 0xa1e700, 0xffffffff, 0xa25700, 0xffffffff, 0x6a1f00, 0xffffffff, 0xffffffff, 0xffffffff
.long 0xffffffff, 0xffffffff, 0xffffffff, 0xffffffff, 0xffffffff, 0xffffffff, 0xffffffff, 0xffffffff
.long 0x9aee00, 0xffffffff, 0x322600, 0xffffffff, 0xd32600, 0xffffffff, 0xffffffff, 0xffffffff
.long 0xffffffff, 0xffffffff, 0xffffffff, 0xffffffff, 0xffffffff, 0xffffffff, 0xffffffff, 0xffffffff
.long 0xa1f500, 0xffffffff, 0xa26500, 0xffffffff, 0x6a2d00, 0xffffffff, 0xffffffff, 0xffffffff
.long 0xffffffff, 0xffffffff, 0xffffffff, 0xffffffff, 0xffffffff, 0xffffffff, 0xffffffff, 0xffffffff
.long 0xa1fc00, 0xffffffff, 0xda6c00, 0xffffffff, 0xa23400, 0xffffffff, 0xffffffff, 0xffffffff
.long 0xffffffff, 0xffffffff, 0xffffffff, 0xffffffff, 0xffffffff, 0xffffffff, 0xffffffff, 0xffffffff
.long 0x9b0300, 0xffffffff, 0xbe7300, 0xffffffff, 0x7f3b00, 0xffffffff, 0xffffffff, 0xffffffff
.long 0xffffffff, 0xffffffff, 0xffffffff, 0xffffffff, 0xffffffff, 0xffffffff, 0xffffffff, 0xffffffff
.long 0xa20a00, 0xffffffff, 0x864200, 0xffffffff, 0xffffffff, 0xffffffff, 0xffffffff, 0xffffffff
.long 0xffffffff, 0xffffffff, 0xffffffff, 0xffffffff, 0xffffffff, 0xffffffff, 0xffffffff, 0xffffffff
.long 0xa21100, 0xffffffff, 0xda8100, 0xffffffff, 0xa24900, 0xffffffff, 0xffffffff, 0xffffffff
.long 0xffffffff, 0xffffffff, 0xffffffff, 0xffffffff, 0xffffffff, 0xffffffff, 0xffffffff, 0xffffffff
.long 0xe0181, 0xe0580, 0xe7181, 0xe7580, 0x478800, 0xf5000, 0x638800, 0x2b5000
.long 0x7f8800, 0xffffffff, 0x9b8800, 0xffffffff, 0xb78800, 0xffffffff, 0xd38800, 0xffffffff
.long 0xe0981, 0xe0d80, 0xe7981, 0xe7d80, 0x478f00, 0xf5700, 0x638f00, 0x2b5700
.long 0x7f8f00, 0xffffffff, 0x9b8f00, 0xffffffff, 0xb78f00, 0xffffffff, 0xd38f00, 0xffffffff
.long 0xe1181, 0xe4980, 0x479600, 0x7f5e00, 0x7f9600, 0x9b5e00, 0xb79600, 0xb75e00
.long 0xf5e00, 0xffffffff, 0x2b5e00, 0xffffffff, 0x475e00, 0xffffffff, 0x635e00, 0xffffffff
.long 0xe1581, 0xe1980, 0xe8581, 0xe8980, 0x479d00, 0xf6500, 0x639d00, 0x2b6500
.long 0x7f9d00, 0xffffffff, 0x9b9d00, 0xffffffff, 0xb79d00, 0xffffffff, 0xd39d00, 0xffffffff
.long 0xe1d81, 0xe2180, 0xe8d81, 0xe9180, 0x47a400, 0xf6c00, 0x63a400, 0x2b6c00
.long 0x7fa400, 0xffffffff, 0x9ba400, 0xffffffff, 0xb7a400, 0xffffffff, 0xd3a400, 0xffffffff
.long 0xe2581, 0xe2980, 0xe9581, 0xe9980, 0x47ab00, 0xf7300, 0x63ab00, 0x2b7300
.long 0x7fab00, 0xffffffff, 0x9bab00, 0xffffffff, 0xb7ab00, 0xffffffff, 0xd3ab00, 0xffffffff
.long 0xe2d81, 0xe6580, 0x47b200, 0x7f7a00, 0x7fb200, 0x9b7a00, 0xb7b200, 0xb77a00
.long 0xf7a00, 0xffffffff, 0x2b7a00, 0xffffffff, 0x477a00, 0xffffffff, 0x637a00, 0xffffffff
.long 0xe3181, 0xe3580, 0xea181, 0xea580, 0x47b900, 0xf8100, 0x63b900, 0x2b8100
.long 0x7fb900, 0xffffffff, 0x9bb900, 0xffffffff, 0xb7b900, 0xffffffff, 0xd3b900, 0xffffffff
.long 0xe3981, 0xe3d80, 0xea981, 0xead80, 0x4e8800, 0x165000, 0x6a8800, 0x325000
.long 0x868800, 0xffffffff, 0xa28800, 0xffffffff, 0xbe8800, 0xffffffff, 0xda8800, 0xffffffff
.long 0xe4181, 0xe4580, 0xeb181, 0xeb580, 0x4e8f00, 0x165700, 0x6a8f00, 0x325700
.long 0x868f00, 0xffffffff, 0xa28f00, 0xffffffff, 0xbe8f00, 0xffffffff, 0xda8f00, 0xffffffff
.long 0xe8181, 0xeb980, 0x639600, 0x865e00, 0x9b9600, 0xa25e00, 0xd39600, 0xbe5e00
.long 0x165e00, 0xffffffff, 0x325e00, 0xffffffff, 0x4e5e00, 0xffffffff, 0x6a5e00, 0xffffffff
.long 0xe4d81, 0xe5180, 0xebd81, 0xec180, 0x4e9d00, 0x166500, 0x6a9d00, 0x326500
.long 0x869d00, 0xffffffff, 0xa29d00, 0xffffffff, 0xbe9d00, 0xffffffff, 0xda9d00, 0xffffffff
.long 0xe5581, 0xe5980, 0xec581, 0xec980, 0x4ea400, 0x166c00, 0x6aa400, 0x326c00
.long 0x86a400, 0x476c00, 0xa2a400, 0x4e6c00, 0xbea400, 0x636c00, 0xdaa400, 0x6a6c00
.long 0xe5d81, 0xe6180, 0xecd81, 0xed180, 0x4eab00, 0x167300, 0x6aab00, 0x327300
.long 0x86ab00, 0x477300, 0xa2ab00, 0x4e7300, 0xbeab00, 0x637300, 0xdaab00, 0x6a7300
.long 0xe9d81, 0xed580, 0x63b200, 0x867a00, 0x9bb200, 0xa27a00, 0xd3b200, 0xbe7a00
.long 0x167a00, 0xd37a00, 0x327a00, 0xda7a00, 0x4e7a00, 0xf4200, 0x6a7a00, 0x164200
.long 0xe6981, 0xe6d80, 0xed981, 0xedd80, 0x4eb900, 0x168100, 0x6ab900, 0x328100
.long 0x86b900, 0x478100, 0xa2b900, 0x4e8100, 0xbeb900, 0x638100, 0xdab900, 0x6a8100
.p2align 5
tab_vh:
.long 0xffffffff, 0xffffffff, 0xffffffff, 0xffffffff, 0xffffffff, 0xffffffff, 0xffffffff, 0xffffffff
.long 0x348100, 0x310400, 0x3b8f00, 0xffffffff, 0xffffffff, 0xffffffff, 0xffffffff, 0xffffffff
.long 0x380c00, 0x119100, 0xffffffff, 0xffffffff, 0xffffffff, 0xffffffff, 0xffffffff, 0xffffffff
.long 0x118700, 0x428100, 0xffffffff, 0xffffffff, 0xffffffff, 0xffffffff, 0xffffffff, 0xffffffff
.long 0x3b8200, 0x460c00, 0xffffffff, 0xffffffff, 0xffffffff, 0xffffffff, 0xffffffff, 0xffffffff
.long 0x118900, 0x268700, 0xffffffff, 0xffffffff, 0xffffffff, 0xffffffff, 0xffffffff, 0xffffffff
.long 0x188f00, 0x70200, 0xffffffff, 0xffffffff, 0xffffffff, 0xffffffff, 0xffffffff, 0xffffffff
.long 0x38a00, 0x348900, 0xffffffff, 0xffffffff, 0xffffffff, 0xffffffff, 0xffffffff, 0xffffffff
.long 0xffffffff, 0xffffffff, 0xffffffff, 0xffffffff, 0xffffffff, 0xffffffff, 0xffffffff, 0xffffffff
.long 0x349500, 0x499700, 0x5b0600, 0xffffffff, 0xffffffff, 0xffffffff, 0xffffffff, 0xffffffff
.long 0x578300, 0x269200, 0xffffffff, 0xffffffff, 0xffffffff, 0xffffffff, 0xffffffff, 0xffffffff
.long 0x269a00, 0x429500, 0xffffffff, 0xffffffff, 0xffffffff, 0xffffffff, 0xffffffff, 0xffffffff
.long 0x1400, 0x658300, 0xffffffff, 0xffffffff, 0xffffffff, 0xffffffff, 0xffffffff, 0xffffffff
.long 0x7a8100, 0x3b9a00, 0xffffffff, 0xffffffff, 0xffffffff, 0xffffffff, 0xffffffff, 0xffffffff
.long 0x888600, 0x1c1400, 0xffffffff, 0xffffffff, 0xffffffff, 0xffffffff, 0xffffffff, 0xffffffff
.long 0x700000, 0x9d8100, 0xffffffff, 0xffffffff, 0xffffffff, 0xffffffff, 0xffffffff, 0xffffffff
.long 0xffffffff, 0xffffffff, 0xffffffff, 0xffffffff, 0xffffffff, 0xffffffff, 0xffffffff, 0xffffffff
.long 0x850900, 0x818c00, 0x8c1700, 0xffffffff, 0xffffffff, 0xffffffff, 0xffffffff, 0xffffffff
.long 0x889400, 0x621900, 0xffffffff, 0xffffffff, 0xffffffff, 0xffffffff, 0xffffffff, 0xffffffff
.long 0x620f00, 0x930900, 0xffffffff, 0xffffffff, 0xffffffff, 0xffffffff, 0xffffffff, 0xffffffff
.long 0x8c0a00, 0x969400, 0xffffffff, 0xffffffff, 0xffffffff, 0xffffffff, 0xffffffff, 0xffffffff
.long 0x621100, 0x770f00, 0xffffffff, 0xffffffff, 0xffffffff, 0xffffffff, 0xffffffff, 0xffffffff
.long 0x691700, 0x578a00, 0xffffffff, 0xffffffff, 0xffffffff, 0xffffffff, 0xffffffff, 0xffffffff
.long 0x541200, 0x851100, 0xffffffff, 0xffffffff, 0xffffffff, 0xffffffff, 0xffffffff, 0xffffffff
.long 0xffffffff, 0xffffffff, 0xffffffff, 0xffffffff, 0xffffffff, 0xffffffff, 0xffffffff, 0xffffffff
.long 0xd58100, 0xa48300, 0xffffffff, 0xffffffff, 0xffffffff, 0xffffffff, 0xffffffff, 0xffffffff
.long 0xb28b00, 0x8f9a00, 0xffffffff, 0xffffffff, 0xffffffff, 0xffffffff, 0xffffffff, 0xffffffff
.long 0xd20600, 0xe38100, 0xffffffff, 0xffffffff, 0xffffffff, 0xffffffff, 0xffffffff, 0xffffffff
.long 0xa80000, 0xc08b00, 0xffffffff, 0xffffffff, 0xffffffff, 0xffffffff, 0xffffffff, 0xffffffff
.long 0xb60900, 0xe70600, 0xffffffff, 0xffffffff, 0xffffffff, 0xffffffff, 0xffffffff, 0xffffffff
.long 0xe00e00, 0xc40000, 0xffffffff, 0xffffffff, 0xffffffff, 0xffffffff, 0xffffffff, 0xffffffff
.long 0xc78800, 0xffffffff, 0xffffffff, 0xffffffff, 0xffffffff, 0xffffffff, 0xffffffff, 0xffffffff
.long 0xffffffff, 0xffffffff, 0xffffffff, 0xffffffff, 0xffffffff, 0xffffffff, 0xffffffff, 0xffffffff
.long 0xd59100, 0xf88000, 0xffffffff, 0xffffffff, 0xffffffff, 0xffffffff, 0xffffffff, 0xffffffff
.long 0x10d8200, 0xb29800, 0xffffffff, 0xffffffff, 0xffffffff, 0xffffffff, 0xffffffff, 0xffffffff
.long 0xc09a00, 0xab9400, 0xffffffff, 0xffffffff, 0xffffffff, 0xffffffff, 0xffffffff, 0xffffffff
.long 0xb29600, 0xa49000, 0xffffffff, 0xffffffff, 0xffffffff, 0xffffffff, 0xffffffff, 0xffffffff
.long 0xa49200, 0xb99500, 0xffffffff, 0xffffffff, 0xffffffff, 0xffffffff, 0xffffffff, 0xffffffff
.long 0xc41900, 0xf50300, 0xffffffff, 0xffffffff, 0xffffffff, 0xffffffff, 0xffffffff, 0xffffffff
.long 0xff8400, 0xffffffff, 0xffffffff, 0xffffffff, 0xffffffff, 0xffffffff, 0xffffffff, 0xffffffff
.long 0xffffffff, 0xffffffff, 0xffffffff, 0xffffffff, 0xffffffff, 0xffffffff, 0xffffffff, 0xffffffff
.long 0x1228500, 0x1229000, 0xffffffff, 0xffffffff, 0xffffffff, 0xffffffff, 0xffffffff, 0xffffffff
.long 0x1379200, 0x11b8c00, 0xffffffff, 0xffffffff, 0xffffffff, 0xffffffff, 0xffffffff, 0xffffffff
.long 0x1298e00, 0x1148800, 0xffffffff, 0xffffffff, 0xffffffff, 0xffffffff, 0xffffffff, 0xffffffff
.long 0x11b8a00, 0x10d9500, 0xffffffff, 0xffffffff, 0xffffffff, 0xffffffff, 0xffffffff, 0xffffffff
.long 0x10d8600, 0x1068900, 0xffffffff, 0xffffffff, 0xffffffff, 0xffffffff, 0xffffffff, 0xffffffff
.long 0x1110d00, 0x11f1300, 0xffffffff, 0xffffffff, 0xffffffff, 0xffffffff, 0xffffffff, 0xffffffff
.long 0x1299400, 0xffffffff, 0xffffffff, 0xffffffff, 0xffffffff, 0xffffffff, 0xffffffff, 0xffffffff
.long 0xffffffff, 0xffffffff, 0xffffffff, 0xffffffff, 0xffffffff, 0xffffffff, 0xffffffff, 0xffffffff
.long 0x1229900, 0x15a8600, 0xffffffff, 0xffffffff, 0xffffffff, 0xffffffff, 0xffffffff, 0xffffffff
.long 0x16f8700, 0x1538200, 0xffffffff, 0xffffffff, 0xffffffff, 0xffffffff, 0xffffffff, 0xffffffff
.long 0x1618300, 0x10a1a00, 0xffffffff, 0xffffffff, 0xffffffff, 0xffffffff, 0xffffffff, 0xffffffff
.long 0x1111b00, 0x1031600, 0xffffffff, 0xffffffff, 0xffffffff, 0xffffffff, 0xffffffff, 0xffffffff
.long 0x1031700, 0x1848100, 0xffffffff, 0xffffffff, 0xffffffff, 0xffffffff, 0xffffffff, 0xffffffff
.long 0x1420500, 0x1570800, 0xffffffff, 0xffffffff, 0xffffffff, 0xffffffff, 0xffffffff, 0xffffffff
.long 0x1618a00, 0xffffffff, 0xffffffff, 0xffffffff, 0xffffffff, 0xffffffff, 0xffffffff, 0xffffffff
.long 0xffffffff, 0xffffffff, 0xffffffff, 0xffffffff, 0xffffffff, 0xffffffff, 0xffffffff, 0xffffffff
.long 0x16f8d00, 0x16f9700, 0xffffffff, 0xffffffff, 0xffffffff, 0xffffffff, 0xffffffff, 0xffffffff
.long 0x1849800, 0x1689300, 0xffffffff, 0xffffffff, 0xffffffff, 0xffffffff, 0xffffffff, 0xffffffff
.long 0x1769400, 0x1618f00, 0xffffffff, 0xffffffff, 0xffffffff, 0xffffffff, 0xffffffff, 0xffffffff
.long 0x1689000, 0x15a8b00, 0xffffffff, 0xffffffff, 0xffffffff, 0xffffffff, 0xffffffff, 0xffffffff
.long 0x15a8c00, 0x1539100, 0xffffffff, 0xffffffff, 0xffffffff, 0xffffffff, 0xffffffff, 0xffffffff
.long 0x15e1500, 0x16c1a00, 0xffffffff, 0xffffffff, 0xffffffff, 0xffffffff, 0xffffffff, 0xffffffff
.long 0x1769b00, 0xffffffff, 0xffffffff, 0xffffffff, 0xffffffff, 0xffffffff, 0xffffffff, 0xffffffff
.long 0xffffffff, 0xffffffff, 0xffffffff, 0xffffffff, 0xffffffff, 0xffffffff, 0xffffffff, 0xffffffff
.long 0x500, 0x600, 0x71000, 0xffffffff, 0xffffffff, 0xffffffff, 0xffffffff, 0xffffffff
.long 0x70e00, 0x2d8000, 0xffffffff, 0xffffffff, 0xffffffff, 0xffffffff, 0xffffffff, 0xffffffff
.long 0x2d8800, 0xe0500, 0xffffffff, 0xffffffff, 0xffffffff, 0xffffffff, 0xffffffff, 0xffffffff
.long 0x70300, 0x150e00, 0xffffffff, 0xffffffff, 0xffffffff, 0xffffffff, 0xffffffff, 0xffffffff
.long 0x310d00, 0x428800, 0xffffffff, 0xffffffff, 0xffffffff, 0xffffffff, 0xffffffff, 0xffffffff
.long 0x349000, 0x230300, 0xffffffff, 0xffffffff, 0xffffffff, 0xffffffff, 0xffffffff, 0xffffffff
.long 0x1f8b00, 0x38d00, 0xffffffff, 0xffffffff, 0xffffffff, 0xffffffff, 0xffffffff, 0xffffffff
.long 0xffffffff, 0xffffffff, 0xffffffff, 0xffffffff, 0xffffffff, 0xffffffff, 0xffffffff, 0xffffffff
.long 0x1900, 0x151800, 0x770700, 0xffffffff, 0xffffffff, 0xffffffff, 0xffffffff, 0xffffffff
.long 0x738400, 0x461300, 0xffffffff, 0xffffffff, 0xffffffff, 0xffffffff, 0xffffffff, 0xffffffff
.long 0x461b00, 0xe1900, 0xffffffff, 0xffffffff, 0xffffffff, 0xffffffff, 0xffffffff, 0xffffffff
.long 0x1c1600, 0x818400, 0xffffffff, 0xffffffff, 0xffffffff, 0xffffffff, 0xffffffff, 0xffffffff
.long 0x968500, 0xa9b00, 0xffffffff, 0xffffffff, 0xffffffff, 0xffffffff, 0xffffffff, 0xffffffff
.long 0x540700, 0x381600, 0xffffffff, 0xffffffff, 0xffffffff, 0xffffffff, 0xffffffff, 0xffffffff
.long 0x8f8200, 0x690500, 0xffffffff, 0xffffffff, 0xffffffff, 0xffffffff, 0xffffffff, 0xffffffff
.long 0xffffffff, 0xffffffff, 0xffffffff, 0xffffffff, 0xffffffff, 0xffffffff, 0xffffffff, 0xffffffff
.long 0x508d00, 0x508e00, 0x579800, 0xffffffff, 0xffffffff, 0xffffffff, 0xffffffff, 0xffffffff
.long 0x579600, 0x7e0800, 0xffffffff, 0xffffffff, 0xffffffff, 0xffffffff, 0xffffffff, 0xffffffff
.long 0x7e1000, 0x5e8d00, 0xffffffff, 0xffffffff, 0xffffffff, 0xffffffff, 0xffffffff, 0xffffffff
.long 0x578b00, 0x659600, 0xffffffff, 0xffffffff, 0xffffffff, 0xffffffff, 0xffffffff, 0xffffffff
.long 0x819500, 0x931000, 0xffffffff, 0xffffffff, 0xffffffff, 0xffffffff, 0xffffffff, 0xffffffff
.long 0x851800, 0x738b00, 0xffffffff, 0xffffffff, 0xffffffff, 0xffffffff, 0xffffffff, 0xffffffff
.long 0x701300, 0x541500, 0xffffffff, 0xffffffff, 0xffffffff, 0xffffffff, 0xffffffff, 0xffffffff
.long 0xffffffff, 0xffffffff, 0xffffffff, 0xffffffff, 0xffffffff, 0xffffffff, 0xffffffff, 0xffffffff
.long 0xa48500, 0xc08400, 0xffffffff, 0xffffffff, 0xffffffff, 0xffffffff, 0xffffffff, 0xffffffff
.long 0xce8c00, 0x5b1b00, 0xffffffff, 0xffffffff, 0xffffffff, 0xffffffff, 0xffffffff, 0xffffffff
.long 0xa48700, 0xb28500, 0xffffffff, 0xffffffff, 0xffffffff, 0xffffffff, 0xffffffff, 0xffffffff
.long 0xc40200, 0xdc8c00, 0xffffffff, 0xffffffff, 0xffffffff, 0xffffffff, 0xffffffff, 0xffffffff
.long 0xd58d00, 0xb98700, 0xffffffff, 0xffffffff, 0xffffffff, 0xffffffff, 0xffffffff, 0xffffffff
.long 0xb28f00, 0xe00200, 0xffffffff, 0xffffffff, 0xffffffff, 0xffffffff, 0xffffffff, 0xffffffff
.long 0xe38a00, 0xffffffff, 0xffffffff, 0xffffffff, 0xffffffff, 0xffffffff, 0xffffffff, 0xffffffff
.long 0xffffffff, 0xffffffff, 0xffffffff, 0xffffffff, 0xffffffff, 0xffffffff, 0xffffffff, 0xffffffff
.long 0xa49500, 0x1148200, 0xffffffff, 0xffffffff, 0xffffffff, 0xffffffff, 0xffffffff, 0xffffffff
.long 0x12d0300, 0xce9a00, 0xffffffff, 0xffffffff, 0xffffffff, 0xffffffff, 0xffffffff, 0xffffffff
.long 0xdc9b00, 0xc79600, 0xffffffff, 0xffffffff, 0xffffffff, 0xffffffff, 0xffffffff, 0xffffffff
.long 0xce9700, 0xc09200, 0xffffffff, 0xffffffff, 0xffffffff, 0xffffffff, 0xffffffff, 0xffffffff
.long 0xc09300, 0xd59900, 0xffffffff, 0xffffffff, 0xffffffff, 0xffffffff, 0xffffffff, 0xffffffff
.long 0x1260100, 0x1110400, 0xffffffff, 0xffffffff, 0xffffffff, 0xffffffff, 0xffffffff, 0xffffffff
.long 0xdc9100, 0xffffffff, 0xffffffff, 0xffffffff, 0xffffffff, 0xffffffff, 0xffffffff, 0xffffffff
.long 0xffffffff, 0xffffffff, 0xffffffff, 0xffffffff, 0xffffffff, 0xffffffff, 0xffffffff, 0xffffffff
.long 0xf18900, 0xf19200, 0xffffffff, 0xffffffff, 0xffffffff, 0xffffffff, 0xffffffff, 0xffffffff
.long 0x10a1300, 0x1378e00, 0xffffffff, 0xffffffff, 0xffffffff, 0xffffffff, 0xffffffff, 0xffffffff
.long 0xfc0f00, 0x1308a00, 0xffffffff, 0xffffffff, 0xffffffff, 0xffffffff, 0xffffffff, 0xffffffff
.long 0xee0b00, 0x1298600, 0xffffffff, 0xffffffff, 0xffffffff, 0xffffffff, 0xffffffff, 0xffffffff
.long 0x12d0700, 0x1228d00, 0xffffffff, 0xffffffff, 0xffffffff, 0xffffffff, 0xffffffff, 0xffffffff
.long 0x1309100, 0xee1400, 0xffffffff, 0xffffffff, 0xffffffff, 0xffffffff, 0xffffffff, 0xffffffff
.long 0x1298500, 0xffffffff, 0xffffffff, 0xffffffff, 0xffffffff, 0xffffffff, 0xffffffff, 0xffffffff
.long 0xffffffff, 0xffffffff, 0xffffffff, 0xffffffff, 0xffffffff, 0xffffffff, 0xffffffff, 0xffffffff
.long 0x16f8100, 0x1768700, 0xffffffff, 0xffffffff, 0xffffffff, 0xffffffff, 0xffffffff, 0xffffffff
.long 0x1420800, 0x16f8300, 0xffffffff, 0xffffffff, 0xffffffff, 0xffffffff, 0xffffffff, 0xffffffff
.long 0x1810400, 0x1261b00, 0xffffffff, 0xffffffff, 0xffffffff, 0xffffffff, 0xffffffff, 0xffffffff
.long 0x1730000, 0x11f1700, 0xffffffff, 0xffffffff, 0xffffffff, 0xffffffff, 0xffffffff, 0xffffffff
.long 0x1229800, 0x1538500, 0xffffffff, 0xffffffff, 0xffffffff, 0xffffffff, 0xffffffff, 0xffffffff
.long 0x15e0900, 0x1730a00, 0xffffffff, 0xffffffff, 0xffffffff, 0xffffffff, 0xffffffff, 0xffffffff
.long 0x1299900, 0xffffffff, 0xffffffff, 0xffffffff, 0xffffffff, 0xffffffff, 0xffffffff, 0xffffffff
.long 0xffffffff, 0xffffffff, 0xffffffff, 0xffffffff, 0xffffffff, 0xffffffff, 0xffffffff, 0xffffffff
.long 0x13e9100, 0x13e9800, 0xffffffff, 0xffffffff, 0xffffffff, 0xffffffff, 0xffffffff, 0xffffffff
.long 0x1571a00, 0x1849400, 0xffffffff, 0xffffffff, 0xffffffff, 0xffffffff, 0xffffffff, 0xffffffff
.long 0x1491600, 0x17d9000, 0xffffffff, 0xffffffff, 0xffffffff, 0xffffffff, 0xffffffff, 0xffffffff
.long 0x13b1200, 0x1768c00, 0xffffffff, 0xffffffff, 0xffffffff, 0xffffffff, 0xffffffff, 0xffffffff
.long 0x17a0e00, 0x16f9500, 0xffffffff, 0xffffffff, 0xffffffff, 0xffffffff, 0xffffffff, 0xffffffff
.long 0x17d9900, 0x13b1b00, 0xffffffff, 0xffffffff, 0xffffffff, 0xffffffff, 0xffffffff, 0xffffffff
.long 0x1768d00, 0xffffffff, 0xffffffff, 0xffffffff, 0xffffffff, 0xffffffff, 0xffffffff, 0xffffffff
.long 0xffffffff, 0xffffffff, 0xffffffff, 0xffffffff, 0xffffffff, 0xffffffff, 0xffffffff, 0xffffffff
.long 0x1c0900, 0x1c0700, 0xffffffff, 0xffffffff, 0xffffffff, 0xffffffff, 0xffffffff, 0xffffffff
.long 0x230f00, 0x4d0200, 0xffffffff, 0xffffffff, 0xffffffff, 0xffffffff, 0xffffffff, 0xffffffff
.long 0x4d0a00, 0x2a0900, 0xffffffff, 0xffffffff, 0xffffffff, 0xffffffff, 0xffffffff, 0xffffffff
.long 0x230400, 0x310f00, 0xffffffff, 0xffffffff, 0xffffffff, 0xffffffff, 0xffffffff, 0xffffffff
.long 0x4d1100, 0x118a00, 0xffffffff, 0xffffffff, 0xffffffff, 0xffffffff, 0xffffffff, 0xffffffff
.long 0x380100, 0x3f0400, 0xffffffff, 0xffffffff, 0xffffffff, 0xffffffff, 0xffffffff, 0xffffffff
.long 0x3b8c00, 0x1f9100, 0xffffffff, 0xffffffff, 0xffffffff, 0xffffffff, 0xffffffff, 0xffffffff
.long 0xffffffff, 0xffffffff, 0xffffffff, 0xffffffff, 0xffffffff, 0xffffffff, 0xffffffff, 0xffffffff
.long 0x850100, 0x311a00, 0xffffffff, 0xffffffff, 0xffffffff, 0xffffffff, 0xffffffff, 0xffffffff
.long 0x930600, 0x119400, 0xffffffff, 0xffffffff, 0xffffffff, 0xffffffff, 0xffffffff, 0xffffffff
.long 0x690000, 0x930100, 0xffffffff, 0xffffffff, 0xffffffff, 0xffffffff, 0xffffffff, 0xffffffff
.long 0x3b9700, 0x508600, 0xffffffff, 0xffffffff, 0xffffffff, 0xffffffff, 0xffffffff, 0xffffffff
.long 0x119200, 0x7e0000, 0xffffffff, 0xffffffff, 0xffffffff, 0xffffffff, 0xffffffff, 0xffffffff
.long 0x381500, 0x71700, 0xffffffff, 0xffffffff, 0xffffffff, 0xffffffff, 0xffffffff, 0xffffffff
.long 0x5b0300, 0x349200, 0xffffffff, 0xffffffff, 0xffffffff, 0xffffffff, 0xffffffff, 0xffffffff
.long 0xffffffff, 0xffffffff, 0xffffffff, 0xffffffff, 0xffffffff, 0xffffffff, 0xffffffff, 0xffffffff
.long 0x6c9100, 0x6c8f00, 0xffffffff, 0xffffffff, 0xffffffff, 0xffffffff, 0xffffffff, 0xffffffff
.long 0x739700, 0x9d8a00, 0xffffffff, 0xffffffff, 0xffffffff, 0xffffffff, 0xffffffff, 0xffffffff
.long 0x9d9200, 0x7a9100, 0xffffffff, 0xffffffff, 0xffffffff, 0xffffffff, 0xffffffff, 0xffffffff
.long 0x738c00, 0x819700, 0xffffffff, 0xffffffff, 0xffffffff, 0xffffffff, 0xffffffff, 0xffffffff
.long 0x9d9900, 0x621200, 0xffffffff, 0xffffffff, 0xffffffff, 0xffffffff, 0xffffffff, 0xffffffff
.long 0x888900, 0x8f8c00, 0xffffffff, 0xffffffff, 0xffffffff, 0xffffffff, 0xffffffff, 0xffffffff
.long 0x8c1400, 0x701900, 0xffffffff, 0xffffffff, 0xffffffff, 0xffffffff, 0xffffffff, 0xffffffff
.long 0xffffffff, 0xffffffff, 0xffffffff, 0xffffffff, 0xffffffff, 0xffffffff, 0xffffffff, 0xffffffff
.long 0xc08900, 0xdc8600, 0xffffffff, 0xffffffff, 0xffffffff, 0xffffffff, 0xffffffff, 0xffffffff
.long 0xea8e00, 0xb98000, 0xffffffff, 0xffffffff, 0xffffffff, 0xffffffff, 0xffffffff, 0xffffffff
.long 0xc08800, 0xce8900, 0xffffffff, 0xffffffff, 0xffffffff, 0xffffffff, 0xffffffff, 0xffffffff
.long 0xe38300, 0xab8e00, 0xffffffff, 0xffffffff, 0xffffffff, 0xffffffff, 0xffffffff, 0xffffffff
.long 0x7a9a00, 0xd58800, 0xffffffff, 0xffffffff, 0xffffffff, 0xffffffff, 0xffffffff, 0xffffffff
.long 0xd90100, 0xb28300, 0xffffffff, 0xffffffff, 0xffffffff, 0xffffffff, 0xffffffff, 0xffffffff
.long 0xb60b00, 0xffffffff, 0xffffffff, 0xffffffff, 0xffffffff, 0xffffffff, 0xffffffff, 0xffffffff
.long 0xffffffff, 0xffffffff, 0xffffffff, 0xffffffff, 0xffffffff, 0xffffffff, 0xffffffff, 0xffffffff
.long 0xc09900, 0x1340300, 0xffffffff, 0xffffffff, 0xffffffff, 0xffffffff, 0xffffffff, 0xffffffff
.long 0xfc0400, 0xea9b00, 0xffffffff, 0xffffffff, 0xffffffff, 0xffffffff, 0xffffffff, 0xffffffff
.long 0xee0000, 0xe39700, 0xffffffff, 0xffffffff, 0xffffffff, 0xffffffff, 0xffffffff, 0xffffffff
.long 0xa11800, 0xdc9300, 0xffffffff, 0xffffffff, 0xffffffff, 0xffffffff, 0xffffffff, 0xffffffff
.long 0xe01400, 0x1378100, 0xffffffff, 0xffffffff, 0xffffffff, 0xffffffff, 0xffffffff, 0xffffffff
.long 0xe39000, 0xffffffff, 0xffffffff, 0xffffffff, 0xffffffff, 0xffffffff, 0xffffffff, 0xffffffff
.long 0xab9500, 0xffffffff, 0xffffffff, 0xffffffff, 0xffffffff, 0xffffffff, 0xffffffff, 0xffffffff
.long 0xffffffff, 0xffffffff, 0xffffffff, 0xffffffff, 0xffffffff, 0xffffffff, 0xffffffff, 0xffffffff
.long 0x10d8d00, 0x1111300, 0xffffffff, 0xffffffff, 0xffffffff, 0xffffffff, 0xffffffff, 0xffffffff
.long 0x1261400, 0x10a0f00, 0xffffffff, 0xffffffff, 0xffffffff, 0xffffffff, 0xffffffff, 0xffffffff
.long 0x1181000, 0x1030b00, 0xffffffff, 0xffffffff, 0xffffffff, 0xffffffff, 0xffffffff, 0xffffffff
.long 0x10a0c00, 0xfc0700, 0xffffffff, 0xffffffff, 0xffffffff, 0xffffffff, 0xffffffff, 0xffffffff
.long 0xfc0800, 0xf51100, 0xffffffff, 0xffffffff, 0xffffffff, 0xffffffff, 0xffffffff, 0xffffffff
.long 0xff9500, 0xffffffff, 0xffffffff, 0xffffffff, 0xffffffff, 0xffffffff, 0xffffffff, 0xffffffff
.long 0xf88900, 0xffffffff, 0xffffffff, 0xffffffff, 0xffffffff, 0xffffffff, 0xffffffff, 0xffffffff
.long 0xffffffff, 0xffffffff, 0xffffffff, 0xffffffff, 0xffffffff, 0xffffffff, 0xffffffff, 0xffffffff
.long 0x13e8500, 0x1490800, 0xffffffff, 0xffffffff, 0xffffffff, 0xffffffff, 0xffffffff, 0xffffffff
.long 0x15e0a00, 0x1420400, 0xffffffff, 0xffffffff, 0xffffffff, 0xffffffff, 0xffffffff, 0xffffffff
.long 0x1500600, 0x13b0000, 0xffffffff, 0xffffffff, 0xffffffff, 0xffffffff, 0xffffffff, 0xffffffff
.long 0x1420200, 0xf19800, 0xffffffff, 0xffffffff, 0xffffffff, 0xffffffff, 0xffffffff, 0xffffffff
.long 0xf19a00, 0x16f8900, 0xffffffff, 0xffffffff, 0xffffffff, 0xffffffff, 0xffffffff, 0xffffffff
.long 0xf51600, 0xffffffff, 0xffffffff, 0xffffffff, 0xffffffff, 0xffffffff, 0xffffffff, 0xffffffff
.long 0x1768100, 0xffffffff, 0xffffffff, 0xffffffff, 0xffffffff, 0xffffffff, 0xffffffff, 0xffffffff
.long 0xffffffff, 0xffffffff, 0xffffffff, 0xffffffff, 0xffffffff, 0xffffffff, 0xffffffff, 0xffffffff
.long 0x15a9500, 0x15e1a00, 0xffffffff, 0xffffffff, 0xffffffff, 0xffffffff, 0xffffffff, 0xffffffff
.long 0x1731b00, 0x1571600, 0xffffffff, 0xffffffff, 0xffffffff, 0xffffffff, 0xffffffff, 0xffffffff
.long 0x1651700, 0x1501200, 0xffffffff, 0xffffffff, 0xffffffff, 0xffffffff, 0xffffffff, 0xffffffff
.long 0x1571300, 0x1490e00, 0xffffffff, 0xffffffff, 0xffffffff, 0xffffffff, 0xffffffff, 0xffffffff
.long 0x1490f00, 0x1421900, 0xffffffff, 0xffffffff, 0xffffffff, 0xffffffff, 0xffffffff, 0xffffffff
.long 0x14c8b00, 0xffffffff, 0xffffffff, 0xffffffff, 0xffffffff, 0xffffffff, 0xffffffff, 0xffffffff
.long 0x1459100, 0xffffffff, 0xffffffff, 0xffffffff, 0xffffffff, 0xffffffff, 0xffffffff, 0xffffffff
.long 0xffffffff, 0xffffffff, 0xffffffff, 0xffffffff, 0xffffffff, 0xffffffff, 0xffffffff, 0xffffffff
.long 0x3b8d00, 0x380800, 0xffffffff, 0xffffffff, 0xffffffff, 0xffffffff, 0xffffffff, 0xffffffff
.long 0x3f1000, 0x188300, 0xffffffff, 0xffffffff, 0xffffffff, 0xffffffff, 0xffffffff, 0xffffffff
.long 0x188b00, 0x498d00, 0xffffffff, 0xffffffff, 0xffffffff, 0xffffffff, 0xffffffff, 0xffffffff
.long 0x428600, 0x4d1000, 0xffffffff, 0xffffffff, 0xffffffff, 0xffffffff, 0xffffffff, 0xffffffff
.long 0x188000, 0x2d8b00, 0xffffffff, 0xffffffff, 0xffffffff, 0xffffffff, 0xffffffff, 0xffffffff
.long 0x38500, 0xe0600, 0xffffffff, 0xffffffff, 0xffffffff, 0xffffffff, 0xffffffff, 0xffffffff
.long 0xa8e00, 0x3b8000, 0xffffffff, 0xffffffff, 0xffffffff, 0xffffffff, 0xffffffff, 0xffffffff
.long 0xffffffff, 0xffffffff, 0xffffffff, 0xffffffff, 0xffffffff, 0xffffffff, 0xffffffff, 0xffffffff
.long 0x508500, 0x1b00, 0xffffffff, 0xffffffff, 0xffffffff, 0xffffffff, 0xffffffff, 0xffffffff
.long 0x5e8700, 0x2d9600, 0xffffffff, 0xffffffff, 0xffffffff, 0xffffffff, 0xffffffff, 0xffffffff
.long 0x888200, 0x5e8500, 0xffffffff, 0xffffffff, 0xffffffff, 0xffffffff, 0xffffffff, 0xffffffff
.long 0x71800, 0x6c8700, 0xffffffff, 0xffffffff, 0xffffffff, 0xffffffff, 0xffffffff, 0xffffffff
.long 0x311300, 0x9d8200, 0xffffffff, 0xffffffff, 0xffffffff, 0xffffffff, 0xffffffff, 0xffffffff
.long 0x39900, 0x231800, 0xffffffff, 0xffffffff, 0xffffffff, 0xffffffff, 0xffffffff, 0xffffffff
.long 0x770400, 0x39300, 0xffffffff, 0xffffffff, 0xffffffff, 0xffffffff, 0xffffffff, 0xffffffff
.long 0xffffffff, 0xffffffff, 0xffffffff, 0xffffffff, 0xffffffff, 0xffffffff, 0xffffffff, 0xffffffff
.long 0x8c1500, 0x889000, 0xffffffff, 0xffffffff, 0xffffffff, 0xffffffff, 0xffffffff, 0xffffffff
.long 0x8f9800, 0x690b00, 0xffffffff, 0xffffffff, 0xffffffff, 0xffffffff, 0xffffffff, 0xffffffff
.long 0x691300, 0x9a1500, 0xffffffff, 0xffffffff, 0xffffffff, 0xffffffff, 0xffffffff, 0xffffffff
.long 0x930e00, 0x9d9800, 0xffffffff, 0xffffffff, 0xffffffff, 0xffffffff, 0xffffffff, 0xffffffff
.long 0x690800, 0x7e1300, 0xffffffff, 0xffffffff, 0xffffffff, 0xffffffff, 0xffffffff, 0xffffffff
.long 0x540d00, 0x5e8e00, 0xffffffff, 0xffffffff, 0xffffffff, 0xffffffff, 0xffffffff, 0xffffffff
.long 0x5b1600, 0x8c0800, 0xffffffff, 0xffffffff, 0xffffffff, 0xffffffff, 0xffffffff, 0xffffffff
.long 0xffffffff, 0xffffffff, 0xffffffff, 0xffffffff, 0xffffffff, 0xffffffff, 0xffffffff, 0xffffffff
.long 0xe00d00, 0xaf0700, 0xffffffff, 0xffffffff, 0xffffffff, 0xffffffff, 0xffffffff, 0xffffffff
.long 0xbd0f00, 0xd58200, 0xffffffff, 0xffffffff, 0xffffffff, 0xffffffff, 0xffffffff, 0xffffffff
.long 0xdc8a00, 0xa10d00, 0xffffffff, 0xffffffff, 0xffffffff, 0xffffffff, 0xffffffff, 0xffffffff
.long 0xb28400, 0xcb0f00, 0xffffffff, 0xffffffff, 0xffffffff, 0xffffffff, 0xffffffff, 0xffffffff
.long 0x969b00, 0xa48a00, 0xffffffff, 0xffffffff, 0xffffffff, 0xffffffff, 0xffffffff, 0xffffffff
.long 0xa80500, 0xce8400, 0xffffffff, 0xffffffff, 0xffffffff, 0xffffffff, 0xffffffff, 0xffffffff
.long 0xd20c00, 0xffffffff, 0xffffffff, 0xffffffff, 0xffffffff, 0xffffffff, 0xffffffff, 0xffffffff
.long 0xffffffff, 0xffffffff, 0xffffffff, 0xffffffff, 0xffffffff, 0xffffffff, 0xffffffff, 0xffffffff
.long 0x1228100, 0x1030400, 0xffffffff, 0xffffffff, 0xffffffff, 0xffffffff, 0xffffffff, 0xffffffff
.long 0xd21100, 0xfc0000, 0xffffffff, 0xffffffff, 0xffffffff, 0xffffffff, 0xffffffff, 0xffffffff
.long 0x10a0200, 0xb61800, 0xffffffff, 0xffffffff, 0xffffffff, 0xffffffff, 0xffffffff, 0xffffffff
.long 0xbd1a00, 0xaf1400, 0xffffffff, 0xffffffff, 0xffffffff, 0xffffffff, 0xffffffff, 0xffffffff
.long 0xaf1600, 0xa81000, 0xffffffff, 0xffffffff, 0xffffffff, 0xffffffff, 0xffffffff, 0xffffffff
.long 0xb29200, 0xffffffff, 0xffffffff, 0xffffffff, 0xffffffff, 0xffffffff, 0xffffffff, 0xffffffff
.long 0xc79900, 0xffffffff, 0xffffffff, 0xffffffff, 0xffffffff, 0xffffffff, 0xffffffff, 0xffffffff
.long 0xffffffff, 0xffffffff, 0xffffffff, 0xffffffff, 0xffffffff, 0xffffffff, 0xffffffff, 0xffffffff
.long 0x12d1100, 0x12d1400, 0xffffffff, 0xffffffff, 0xffffffff, 0xffffffff, 0xffffffff, 0xffffffff
.long 0x11f0500, 0x1261000, 0xffffffff, 0xffffffff, 0xffffffff, 0xffffffff, 0xffffffff, 0xffffffff
.long 0x1341200, 0x11f0c00, 0xffffffff, 0xffffffff, 0xffffffff, 0xffffffff, 0xffffffff, 0xffffffff
.long 0x1260e00, 0x1180800, 0xffffffff, 0xffffffff, 0xffffffff, 0xffffffff, 0xffffffff, 0xffffffff
.long 0x1180a00, 0x1111500, 0xffffffff, 0xffffffff, 0xffffffff, 0xffffffff, 0xffffffff, 0xffffffff
.long 0x11b8600, 0xffffffff, 0xffffffff, 0xffffffff, 0xffffffff, 0xffffffff, 0xffffffff, 0xffffffff
.long 0x1148d00, 0xffffffff, 0xffffffff, 0xffffffff, 0xffffffff, 0xffffffff, 0xffffffff, 0xffffffff
.long 0xffffffff, 0xffffffff, 0xffffffff, 0xffffffff, 0xffffffff, 0xffffffff, 0xffffffff, 0xffffffff
.long 0x15a8900, 0x1650a00, 0xffffffff, 0xffffffff, 0xffffffff, 0xffffffff, 0xffffffff, 0xffffffff
.long 0x11f1900, 0x15e0600, 0xffffffff, 0xffffffff, 0xffffffff, 0xffffffff, 0xffffffff, 0xffffffff
.long 0x16c0700, 0x1570200, 0xffffffff, 0xffffffff, 0xffffffff, 0xffffffff, 0xffffffff, 0xffffffff
.long 0x15e0300, 0x10d9a00, 0xffffffff, 0xffffffff, 0xffffffff, 0xffffffff, 0xffffffff, 0xffffffff
.long 0x10d9b00, 0x1069600, 0xffffffff, 0xffffffff, 0xffffffff, 0xffffffff, 0xffffffff, 0xffffffff
.long 0x1111700, 0xffffffff, 0xffffffff, 0xffffffff, 0xffffffff, 0xffffffff, 0xffffffff, 0xffffffff
.long 0x1458500, 0xffffffff, 0xffffffff, 0xffffffff, 0xffffffff, 0xffffffff, 0xffffffff, 0xffffffff
.long 0xffffffff, 0xffffffff, 0xffffffff, 0xffffffff, 0xffffffff, 0xffffffff, 0xffffffff, 0xffffffff
.long 0x17a1900, 0x17a1b00, 0xffffffff, 0xffffffff, 0xffffffff, 0xffffffff, 0xffffffff, 0xffffffff
.long 0x16c0d00, 0x1731700, 0xffffffff, 0xffffffff, 0xffffffff, 0xffffffff, 0xffffffff, 0xffffffff
.long 0x1811800, 0x16c1300, 0xffffffff, 0xffffffff, 0xffffffff, 0xffffffff, 0xffffffff, 0xffffffff
.long 0x1731400, 0x1650f00, 0xffffffff, 0xffffffff, 0xffffffff, 0xffffffff, 0xffffffff, 0xffffffff
.long 0x1651000, 0x15e0b00, 0xffffffff, 0xffffffff, 0xffffffff, 0xffffffff, 0xffffffff, 0xffffffff
.long 0x1688c00, 0xffffffff, 0xffffffff, 0xffffffff, 0xffffffff, 0xffffffff, 0xffffffff, 0xffffffff
.long 0x1619500, 0xffffffff, 0xffffffff, 0xffffffff, 0xffffffff, 0xffffffff, 0xffffffff, 0xffffffff
.long 0xffffffff, 0xffffffff, 0xffffffff, 0xffffffff, 0xffffffff, 0xffffffff, 0xffffffff, 0xffffffff
.long 0x71100, 0x70a00, 0xffffffff, 0xffffffff, 0xffffffff, 0xffffffff, 0xffffffff, 0xffffffff
.long 0x310100, 0x348400, 0xffffffff, 0xffffffff, 0xffffffff, 0xffffffff, 0xffffffff, 0xffffffff
.long 0x348c00, 0x151100, 0xffffffff, 0xffffffff, 0xffffffff, 0xffffffff, 0xffffffff, 0xffffffff
.long 0xe0700, 0x460100, 0xffffffff, 0xffffffff, 0xffffffff, 0xffffffff, 0xffffffff, 0xffffffff
.long 0x380200, 0x498c00, 0xffffffff, 0xffffffff, 0xffffffff, 0xffffffff, 0xffffffff, 0xffffffff
.long 0x1f8900, 0x2a0700, 0xffffffff, 0xffffffff, 0xffffffff, 0xffffffff, 0xffffffff, 0xffffffff
.long 0x268f00, 0xa8200, 0xffffffff, 0xffffffff, 0xffffffff, 0xffffffff, 0xffffffff, 0xffffffff
.long 0xffffffff, 0xffffffff, 0xffffffff, 0xffffffff, 0xffffffff, 0xffffffff, 0xffffffff, 0xffffffff
.long 0x1c1200, 0x738000, 0xffffffff, 0xffffffff, 0xffffffff, 0xffffffff, 0xffffffff, 0xffffffff
.long 0x311500, 0x4d1700, 0xffffffff, 0xffffffff, 0xffffffff, 0xffffffff, 0xffffffff, 0xffffffff
.long 0x540300, 0x2a1200, 0xffffffff, 0xffffffff, 0xffffffff, 0xffffffff, 0xffffffff, 0xffffffff
.long 0x231a00, 0x461500, 0xffffffff, 0xffffffff, 0xffffffff, 0xffffffff, 0xffffffff, 0xffffffff
.long 0x4d1400, 0x690300, 0xffffffff, 0xffffffff, 0xffffffff, 0xffffffff, 0xffffffff, 0xffffffff
.long 0x888100, 0x3f1a00, 0xffffffff, 0xffffffff, 0xffffffff, 0xffffffff, 0xffffffff, 0xffffffff
.long 0x968600, 0x1f9400, 0xffffffff, 0xffffffff, 0xffffffff, 0xffffffff, 0xffffffff, 0xffffffff
.long 0xffffffff, 0xffffffff, 0xffffffff, 0xffffffff, 0xffffffff, 0xffffffff, 0xffffffff, 0xffffffff
.long 0x579900, 0x579200, 0xffffffff, 0xffffffff, 0xffffffff, 0xffffffff, 0xffffffff, 0xffffffff
.long 0x818900, 0x850c00, 0xffffffff, 0xffffffff, 0xffffffff, 0xffffffff, 0xffffffff, 0xffffffff
.long 0x851400, 0x659900, 0xffffffff, 0xffffffff, 0xffffffff, 0xffffffff, 0xffffffff, 0xffffffff
.long 0x5e8f00, 0x968900, 0xffffffff, 0xffffffff, 0xffffffff, 0xffffffff, 0xffffffff, 0xffffffff
.long 0x888a00, 0x9a1400, 0xffffffff, 0xffffffff, 0xffffffff, 0xffffffff, 0xffffffff, 0xffffffff
.long 0x701100, 0x7a8f00, 0xffffffff, 0xffffffff, 0xffffffff, 0xffffffff, 0xffffffff, 0xffffffff
.long 0x771700, 0x5b0a00, 0xffffffff, 0xffffffff, 0xffffffff, 0xffffffff, 0xffffffff, 0xffffffff
.long 0xffffffff, 0xffffffff, 0xffffffff, 0xffffffff, 0xffffffff, 0xffffffff, 0xffffffff, 0xffffffff
.long 0x851a00, 0xcb0800, 0xffffffff, 0xffffffff, 0xffffffff, 0xffffffff, 0xffffffff, 0xffffffff
.long 0xd20100, 0xa80300, 0xffffffff, 0xffffffff, 0xffffffff, 0xffffffff, 0xffffffff, 0xffffffff
.long 0xaf0b00, 0x931a00, 0xffffffff, 0xffffffff, 0xffffffff, 0xffffffff, 0xffffffff, 0xffffffff
.long 0xce8600, 0xe70100, 0xffffffff, 0xffffffff, 0xffffffff, 0xffffffff, 0xffffffff, 0xffffffff
.long 0xa48000, 0xc40b00, 0xffffffff, 0xffffffff, 0xffffffff, 0xffffffff, 0xffffffff, 0xffffffff
.long 0xc40900, 0xea8600, 0xffffffff, 0xffffffff, 0xffffffff, 0xffffffff, 0xffffffff, 0xffffffff
.long 0xa10e00, 0xffffffff, 0xffffffff, 0xffffffff, 0xffffffff, 0xffffffff, 0xffffffff, 0xffffffff
.long 0xffffffff, 0xffffffff, 0xffffffff, 0xffffffff, 0xffffffff, 0xffffffff, 0xffffffff, 0xffffffff
.long 0xe01000, 0xe01100, 0xffffffff, 0xffffffff, 0xffffffff, 0xffffffff, 0xffffffff, 0xffffffff
.long 0xa11500, 0x1180200, 0xffffffff, 0xffffffff, 0xffffffff, 0xffffffff, 0xffffffff, 0xffffffff
.long 0x1298300, 0xd21a00, 0xffffffff, 0xffffffff, 0xffffffff, 0xffffffff, 0xffffffff, 0xffffffff
.long 0xd91b00, 0xcb1600, 0xffffffff, 0xffffffff, 0xffffffff, 0xffffffff, 0xffffffff, 0xffffffff
.long 0xcb1700, 0xc41200, 0xffffffff, 0xffffffff, 0xffffffff, 0xffffffff, 0xffffffff, 0xffffffff
.long 0xce9300, 0xffffffff, 0xffffffff, 0xffffffff, 0xffffffff, 0xffffffff, 0xffffffff, 0xffffffff
.long 0x1298100, 0xffffffff, 0xffffffff, 0xffffffff, 0xffffffff, 0xffffffff, 0xffffffff, 0xffffffff
.long 0xffffffff, 0xffffffff, 0xffffffff, 0xffffffff, 0xffffffff, 0xffffffff, 0xffffffff, 0xffffffff
.long 0xfc1500, 0x12d0500, 0xffffffff, 0xffffffff, 0xffffffff, 0xffffffff, 0xffffffff, 0xffffffff
.long 0xee0900, 0xf51200, 0xffffffff, 0xffffffff, 0xffffffff, 0xffffffff, 0xffffffff, 0xffffffff
.long 0x1069300, 0xee0e00, 0xffffffff, 0xffffffff, 0xffffffff, 0xffffffff, 0xffffffff, 0xffffffff
.long 0xf88f00, 0x1340a00, 0xffffffff, 0xffffffff, 0xffffffff, 0xffffffff, 0xffffffff, 0xffffffff
.long 0x1378b00, 0x12d0600, 0xffffffff, 0xffffffff, 0xffffffff, 0xffffffff, 0xffffffff, 0xffffffff
.long 0xee0700, 0xffffffff, 0xffffffff, 0xffffffff, 0xffffffff, 0xffffffff, 0xffffffff, 0xffffffff
.long 0x1341100, 0xffffffff, 0xffffffff, 0xffffffff, 0xffffffff, 0xffffffff, 0xffffffff, 0xffffffff
.long 0xffffffff, 0xffffffff, 0xffffffff, 0xffffffff, 0xffffffff, 0xffffffff, 0xffffffff, 0xffffffff
.long 0xf19600, 0x12d1900, 0xffffffff, 0xffffffff, 0xffffffff, 0xffffffff, 0xffffffff, 0xffffffff
.long 0x16c0100, 0x17a0700, 0xffffffff, 0xffffffff, 0xffffffff, 0xffffffff, 0xffffffff, 0xffffffff
.long 0x13e8800, 0x1730300, 0xffffffff, 0xffffffff, 0xffffffff, 0xffffffff, 0xffffffff, 0xffffffff
.long 0x17d8400, 0x1299b00, 0xffffffff, 0xffffffff, 0xffffffff, 0xffffffff, 0xffffffff, 0xffffffff
.long 0x16f8000, 0x1229700, 0xffffffff, 0xffffffff, 0xffffffff, 0xffffffff, 0xffffffff, 0xffffffff
.long 0x1309800, 0xffffffff, 0xffffffff, 0xffffffff, 0xffffffff, 0xffffffff, 0xffffffff, 0xffffffff
.long 0x1618900, 0xffffffff, 0xffffffff, 0xffffffff, 0xffffffff, 0xffffffff, 0xffffffff, 0xffffffff
.long 0xffffffff, 0xffffffff, 0xffffffff, 0xffffffff, 0xffffffff, 0xffffffff, 0xffffffff, 0xffffffff
.long 0x1490b00, 0x17a0d00, 0xffffffff, 0xffffffff, 0xffffffff, 0xffffffff, 0xffffffff, 0xffffffff
.long 0x13b1100, 0x1421800, 0xffffffff, 0xffffffff, 0xffffffff, 0xffffffff, 0xffffffff, 0xffffffff
.long 0x1539a00, 0x13b1400, 0xffffffff, 0xffffffff, 0xffffffff, 0xffffffff, 0xffffffff, 0xffffffff
.long 0x1459600, 0x1811000, 0xffffffff, 0xffffffff, 0xffffffff, 0xffffffff, 0xffffffff, 0xffffffff
.long 0x1849200, 0x17a0c00, 0xffffffff, 0xffffffff, 0xffffffff, 0xffffffff, 0xffffffff, 0xffffffff
.long 0x13b0e00, 0xffffffff, 0xffffffff, 0xffffffff, 0xffffffff, 0xffffffff, 0xffffffff, 0xffffffff
.long 0x1811900, 0xffffffff, 0xffffffff, 0xffffffff, 0xffffffff, 0xffffffff, 0xffffffff, 0xffffffff
.long 0xffffffff, 0xffffffff, 0xffffffff, 0xffffffff, 0xffffffff, 0xffffffff, 0xffffffff, 0xffffffff
.long 0x230000, 0x230b00, 0xffffffff, 0xffffffff, 0xffffffff, 0xffffffff, 0xffffffff, 0xffffffff
.long 0x4d0500, 0x38600, 0xffffffff, 0xffffffff, 0xffffffff, 0xffffffff, 0xffffffff, 0xffffffff
.long 0x38e00, 0x310000, 0xffffffff, 0xffffffff, 0xffffffff, 0xffffffff, 0xffffffff, 0xffffffff
.long 0x2a0800, 0x118500, 0xffffffff, 0xffffffff, 0xffffffff, 0xffffffff, 0xffffffff, 0xffffffff
.long 0x38300, 0x188e00, 0xffffffff, 0xffffffff, 0xffffffff, 0xffffffff, 0xffffffff, 0xffffffff
.long 0x3f0d00, 0x460800, 0xffffffff, 0xffffffff, 0xffffffff, 0xffffffff, 0xffffffff, 0xffffffff
.long 0x429000, 0x268300, 0xffffffff, 0xffffffff, 0xffffffff, 0xffffffff, 0xffffffff, 0xffffffff
.long 0xffffffff, 0xffffffff, 0xffffffff, 0xffffffff, 0xffffffff, 0xffffffff, 0xffffffff, 0xffffffff
.long 0x3b9300, 0x930200, 0xffffffff, 0xffffffff, 0xffffffff, 0xffffffff, 0xffffffff, 0xffffffff
.long 0x4d1900, 0x189800, 0xffffffff, 0xffffffff, 0xffffffff, 0xffffffff, 0xffffffff, 0xffffffff
.long 0x700400, 0x499300, 0xffffffff, 0xffffffff, 0xffffffff, 0xffffffff, 0xffffffff, 0xffffffff
.long 0x429b00, 0x119900, 0xffffffff, 0xffffffff, 0xffffffff, 0xffffffff, 0xffffffff, 0xffffffff
.long 0x189600, 0x850400, 0xffffffff, 0xffffffff, 0xffffffff, 0xffffffff, 0xffffffff, 0xffffffff
.long 0x540500, 0xe1b00, 0xffffffff, 0xffffffff, 0xffffffff, 0xffffffff, 0xffffffff, 0xffffffff
.long 0x620700, 0x3b9600, 0xffffffff, 0xffffffff, 0xffffffff, 0xffffffff, 0xffffffff, 0xffffffff
.long 0xffffffff, 0xffffffff, 0xffffffff, 0xffffffff, 0xffffffff, 0xffffffff, 0xffffffff, 0xffffffff
.long 0x738800, 0x739300, 0xffffffff, 0xffffffff, 0xffffffff, 0xffffffff, 0xffffffff, 0xffffffff
.long 0x9d8d00, 0x540e00, 0xffffffff, 0xffffffff, 0xffffffff, 0xffffffff, 0xffffffff, 0xffffffff
.long 0x541600, 0x818800, 0xffffffff, 0xffffffff, 0xffffffff, 0xffffffff, 0xffffffff, 0xffffffff
.long 0x7a9000, 0x620d00, 0xffffffff, 0xffffffff, 0xffffffff, 0xffffffff, 0xffffffff, 0xffffffff
.long 0x540b00, 0x691600, 0xffffffff, 0xffffffff, 0xffffffff, 0xffffffff, 0xffffffff, 0xffffffff
.long 0x8f9500, 0x969000, 0xffffffff, 0xffffffff, 0xffffffff, 0xffffffff, 0xffffffff, 0xffffffff
.long 0x931800, 0x770b00, 0xffffffff, 0xffffffff, 0xffffffff, 0xffffffff, 0xffffffff, 0xffffffff
.long 0xffffffff, 0xffffffff, 0xffffffff, 0xffffffff, 0xffffffff, 0xffffffff, 0xffffffff, 0xffffffff
.long 0x509b00, 0xe70a00, 0xffffffff, 0xffffffff, 0xffffffff, 0xffffffff, 0xffffffff, 0xffffffff
.long 0xa10500, 0xc40400, 0xffffffff, 0xffffffff, 0xffffffff, 0xffffffff, 0xffffffff, 0xffffffff
.long 0xcb0c00, 0x5e9b00, 0xffffffff, 0xffffffff, 0xffffffff, 0xffffffff, 0xffffffff, 0xffffffff
.long 0xa10700, 0xb60500, 0xffffffff, 0xffffffff, 0xffffffff, 0xffffffff, 0xffffffff, 0xffffffff
.long 0xc08200, 0xe00c00, 0xffffffff, 0xffffffff, 0xffffffff, 0xffffffff, 0xffffffff, 0xffffffff
.long 0xe38d00, 0xbd0700, 0xffffffff, 0xffffffff, 0xffffffff, 0xffffffff, 0xffffffff, 0xffffffff
.long 0xc08f00, 0xffffffff, 0xffffffff, 0xffffffff, 0xffffffff, 0xffffffff, 0xffffffff, 0xffffffff
.long 0xffffffff, 0xffffffff, 0xffffffff, 0xffffffff, 0xffffffff, 0xffffffff, 0xffffffff, 0xffffffff
.long 0xaf1200, 0xaf1500, 0xffffffff, 0xffffffff, 0xffffffff, 0xffffffff, 0xffffffff, 0xffffffff
.long 0xbd1900, 0x1378300, 0xffffffff, 0xffffffff, 0xffffffff, 0xffffffff, 0xffffffff, 0xffffffff
.long 0xf88400, 0xa11b00, 0xffffffff, 0xffffffff, 0xffffffff, 0xffffffff, 0xffffffff, 0xffffffff
.long 0x1378000, 0xe71700, 0xffffffff, 0xffffffff, 0xffffffff, 0xffffffff, 0xffffffff, 0xffffffff
.long 0xea9800, 0xe01300, 0xffffffff, 0xffffffff, 0xffffffff, 0xffffffff, 0xffffffff, 0xffffffff
.long 0xa11400, 0xffffffff, 0xffffffff, 0xffffffff, 0xffffffff, 0xffffffff, 0xffffffff, 0xffffffff
.long 0xe71000, 0xffffffff, 0xffffffff, 0xffffffff, 0xffffffff, 0xffffffff, 0xffffffff, 0xffffffff
.long 0xffffffff, 0xffffffff, 0xffffffff, 0xffffffff, 0xffffffff, 0xffffffff, 0xffffffff, 0xffffffff
.long 0x1180600, 0xfc0900, 0xffffffff, 0xffffffff, 0xffffffff, 0xffffffff, 0xffffffff, 0xffffffff
.long 0x10a0d00, 0x1149300, 0xffffffff, 0xffffffff, 0xffffffff, 0xffffffff, 0xffffffff, 0xffffffff
.long 0x1229400, 0x10d8f00, 0xffffffff, 0xffffffff, 0xffffffff, 0xffffffff, 0xffffffff, 0xffffffff
.long 0x1149000, 0x1068b00, 0xffffffff, 0xffffffff, 0xffffffff, 0xffffffff, 0xffffffff, 0xffffffff
.long 0x1068c00, 0xff8700, 0xffffffff, 0xffffffff, 0xffffffff, 0xffffffff, 0xffffffff, 0xffffffff
.long 0x10a0800, 0xffffffff, 0xffffffff, 0xffffffff, 0xffffffff, 0xffffffff, 0xffffffff, 0xffffffff
.long 0x1031500, 0xffffffff, 0xffffffff, 0xffffffff, 0xffffffff, 0xffffffff, 0xffffffff, 0xffffffff
.long 0xffffffff, 0xffffffff, 0xffffffff, 0xffffffff, 0xffffffff, 0xffffffff, 0xffffffff, 0xffffffff
.long 0x10d9700, 0x17a0100, 0xffffffff, 0xffffffff, 0xffffffff, 0xffffffff, 0xffffffff, 0xffffffff
.long 0x13b0500, 0x14c8800, 0xffffffff, 0xffffffff, 0xffffffff, 0xffffffff, 0xffffffff, 0xffffffff
.long 0x15a8a00, 0x1458400, 0xffffffff, 0xffffffff, 0xffffffff, 0xffffffff, 0xffffffff, 0xffffffff
.long 0x14c8600, 0x13e8000, 0xffffffff, 0xffffffff, 0xffffffff, 0xffffffff, 0xffffffff, 0xffffffff
.long 0x13e8200, 0xf51800, 0xffffffff, 0xffffffff, 0xffffffff, 0xffffffff, 0xffffffff, 0xffffffff
.long 0xff9a00, 0xffffffff, 0xffffffff, 0xffffffff, 0xffffffff, 0xffffffff, 0xffffffff, 0xffffffff
.long 0xf89600, 0xffffffff, 0xffffffff, 0xffffffff, 0xffffffff, 0xffffffff, 0xffffffff, 0xffffffff
.long 0xffffffff, 0xffffffff, 0xffffffff, 0xffffffff, 0xffffffff, 0xffffffff, 0xffffffff, 0xffffffff
.long 0x1650c00, 0x1491100, 0xffffffff, 0xffffffff, 0xffffffff, 0xffffffff, 0xffffffff, 0xffffffff
.long 0x1571500, 0x1619a00, 0xffffffff, 0xffffffff, 0xffffffff, 0xffffffff, 0xffffffff, 0xffffffff
.long 0x16f9b00, 0x15a9600, 0xffffffff, 0xffffffff, 0xffffffff, 0xffffffff, 0xffffffff, 0xffffffff
.long 0x1619700, 0x1539200, 0xffffffff, 0xffffffff, 0xffffffff, 0xffffffff, 0xffffffff, 0xffffffff
.long 0x1539300, 0x14c8e00, 0xffffffff, 0xffffffff, 0xffffffff, 0xffffffff, 0xffffffff, 0xffffffff
.long 0x1570f00, 0xffffffff, 0xffffffff, 0xffffffff, 0xffffffff, 0xffffffff, 0xffffffff, 0xffffffff
.long 0x1500b00, 0xffffffff, 0xffffffff, 0xffffffff, 0xffffffff, 0xffffffff, 0xffffffff, 0xffffffff
.long 0xffffffff, 0xffffffff, 0xffffffff, 0xffffffff, 0xffffffff, 0xffffffff, 0xffffffff, 0xffffffff
.long 0x428200, 0x3f0c00, 0xffffffff, 0xffffffff, 0xffffffff, 0xffffffff, 0xffffffff, 0xffffffff
.long 0x188900, 0x1f8700, 0xffffffff, 0xffffffff, 0xffffffff, 0xffffffff, 0xffffffff, 0xffffffff
.long 0x1f8f00, 0x200, 0xffffffff, 0xffffffff, 0xffffffff, 0xffffffff, 0xffffffff, 0xffffffff
.long 0x498a00, 0x2d8900, 0xffffffff, 0xffffffff, 0xffffffff, 0xffffffff, 0xffffffff, 0xffffffff
.long 0x1f8400, 0x348f00, 0xffffffff, 0xffffffff, 0xffffffff, 0xffffffff, 0xffffffff, 0xffffffff
.long 0xa9100, 0x150a00, 0xffffffff, 0xffffffff, 0xffffffff, 0xffffffff, 0xffffffff, 0xffffffff
.long 0x3b8100, 0x428400, 0xffffffff, 0xffffffff, 0xffffffff, 0xffffffff, 0xffffffff, 0xffffffff
.long 0xffffffff, 0xffffffff, 0xffffffff, 0xffffffff, 0xffffffff, 0xffffffff, 0xffffffff, 0xffffffff
.long 0x71400, 0x5e8300, 0xffffffff, 0xffffffff, 0xffffffff, 0xffffffff, 0xffffffff, 0xffffffff
.long 0x818100, 0x349a00, 0xffffffff, 0xffffffff, 0xffffffff, 0xffffffff, 0xffffffff, 0xffffffff
.long 0x8f8600, 0x151400, 0xffffffff, 0xffffffff, 0xffffffff, 0xffffffff, 0xffffffff, 0xffffffff
.long 0x658000, 0x968100, 0xffffffff, 0xffffffff, 0xffffffff, 0xffffffff, 0xffffffff, 0xffffffff
.long 0x381700, 0x540600, 0xffffffff, 0xffffffff, 0xffffffff, 0xffffffff, 0xffffffff, 0xffffffff
.long 0x1f9200, 0x818000, 0xffffffff, 0xffffffff, 0xffffffff, 0xffffffff, 0xffffffff, 0xffffffff
.long 0x3b9500, 0xa9700, 0xffffffff, 0xffffffff, 0xffffffff, 0xffffffff, 0xffffffff, 0xffffffff
.long 0xffffffff, 0xffffffff, 0xffffffff, 0xffffffff, 0xffffffff, 0xffffffff, 0xffffffff, 0xffffffff
.long 0x930a00, 0x8f9400, 0xffffffff, 0xffffffff, 0xffffffff, 0xffffffff, 0xffffffff, 0xffffffff
.long 0x691100, 0x700f00, 0xffffffff, 0xffffffff, 0xffffffff, 0xffffffff, 0xffffffff, 0xffffffff
.long 0x701700, 0x508a00, 0xffffffff, 0xffffffff, 0xffffffff, 0xffffffff, 0xffffffff, 0xffffffff
.long 0x9a1200, 0x7e1100, 0xffffffff, 0xffffffff, 0xffffffff, 0xffffffff, 0xffffffff, 0xffffffff
.long 0x700c00, 0x851700, 0xffffffff, 0xffffffff, 0xffffffff, 0xffffffff, 0xffffffff, 0xffffffff
.long 0x5b1900, 0x659200, 0xffffffff, 0xffffffff, 0xffffffff, 0xffffffff, 0xffffffff, 0xffffffff
.long 0x8c0900, 0x930c00, 0xffffffff, 0xffffffff, 0xffffffff, 0xffffffff, 0xffffffff, 0xffffffff
.long 0xffffffff, 0xffffffff, 0xffffffff, 0xffffffff, 0xffffffff, 0xffffffff, 0xffffffff, 0xffffffff
.long 0xaf0000, 0xb98b00, 0xffffffff, 0xffffffff, 0xffffffff, 0xffffffff, 0xffffffff, 0xffffffff
.long 0xbd0900, 0xe00600, 0xffffffff, 0xffffffff, 0xffffffff, 0xffffffff, 0xffffffff, 0xffffffff
.long 0xe70e00, 0xbd0000, 0xffffffff, 0xffffffff, 0xffffffff, 0xffffffff, 0xffffffff, 0xffffffff
.long 0xbd0800, 0xd20900, 0xffffffff, 0xffffffff, 0xffffffff, 0xffffffff, 0xffffffff, 0xffffffff
.long 0xe00300, 0xaf0e00, 0xffffffff, 0xffffffff, 0xffffffff, 0xffffffff, 0xffffffff, 0xffffffff
.long 0x889a00, 0xd90800, 0xffffffff, 0xffffffff, 0xffffffff, 0xffffffff, 0xffffffff, 0xffffffff
.long 0xdc8100, 0xffffffff, 0xffffffff, 0xffffffff, 0xffffffff, 0xffffffff, 0xffffffff, 0xffffffff
.long 0xffffffff, 0xffffffff, 0xffffffff, 0xffffffff, 0xffffffff, 0xffffffff, 0xffffffff, 0xffffffff
.long 0xcb1300, 0xcb1900, 0xffffffff, 0xffffffff, 0xffffffff, 0xffffffff, 0xffffffff, 0xffffffff
.long 0x11f0100, 0x1068400, 0xffffffff, 0xffffffff, 0xffffffff, 0xffffffff, 0xffffffff, 0xffffffff
.long 0xce9100, 0xff8000, 0xffffffff, 0xffffffff, 0xffffffff, 0xffffffff, 0xffffffff, 0xffffffff
.long 0x1068200, 0xb99800, 0xffffffff, 0xffffffff, 0xffffffff, 0xffffffff, 0xffffffff, 0xffffffff
.long 0xb99a00, 0xb29400, 0xffffffff, 0xffffffff, 0xffffffff, 0xffffffff, 0xffffffff, 0xffffffff
.long 0xbd1600, 0xffffffff, 0xffffffff, 0xffffffff, 0xffffffff, 0xffffffff, 0xffffffff, 0xffffffff
.long 0xb61200, 0xffffffff, 0xffffffff, 0xffffffff, 0xffffffff, 0xffffffff, 0xffffffff, 0xffffffff
.long 0xffffffff, 0xffffffff, 0xffffffff, 0xffffffff, 0xffffffff, 0xffffffff, 0xffffffff, 0xffffffff
.long 0x1378700, 0x1180d00, 0xffffffff, 0xffffffff, 0xffffffff, 0xffffffff, 0xffffffff, 0xffffffff
.long 0x1299100, 0x1309400, 0xffffffff, 0xffffffff, 0xffffffff, 0xffffffff, 0xffffffff, 0xffffffff
.long 0x11b8500, 0x1299000, 0xffffffff, 0xffffffff, 0xffffffff, 0xffffffff, 0xffffffff, 0xffffffff
.long 0x1309200, 0x1228c00, 0xffffffff, 0xffffffff, 0xffffffff, 0xffffffff, 0xffffffff, 0xffffffff
.long 0x1228e00, 0x11b8800, 0xffffffff, 0xffffffff, 0xffffffff, 0xffffffff, 0xffffffff, 0xffffffff
.long 0x1260a00, 0xffffffff, 0xffffffff, 0xffffffff, 0xffffffff, 0xffffffff, 0xffffffff, 0xffffffff
.long 0x11f0600, 0xffffffff, 0xffffffff, 0xffffffff, 0xffffffff, 0xffffffff, 0xffffffff, 0xffffffff
.long 0xffffffff, 0xffffffff, 0xffffffff, 0xffffffff, 0xffffffff, 0xffffffff, 0xffffffff, 0xffffffff
.long 0x12d1800, 0x1490500, 0xffffffff, 0xffffffff, 0xffffffff, 0xffffffff, 0xffffffff, 0xffffffff
.long 0x1570900, 0x1688a00, 0xffffffff, 0xffffffff, 0xffffffff, 0xffffffff, 0xffffffff, 0xffffffff
.long 0x11b9900, 0x1618600, 0xffffffff, 0xffffffff, 0xffffffff, 0xffffffff, 0xffffffff, 0xffffffff
.long 0x1688700, 0x15a8200, 0xffffffff, 0xffffffff, 0xffffffff, 0xffffffff, 0xffffffff, 0xffffffff
.long 0x15a8300, 0x1111a00, 0xffffffff, 0xffffffff, 0xffffffff, 0xffffffff, 0xffffffff, 0xffffffff
.long 0x11b9b00, 0xffffffff, 0xffffffff, 0xffffffff, 0xffffffff, 0xffffffff, 0xffffffff, 0xffffffff
.long 0x1149700, 0xffffffff, 0xffffffff, 0xffffffff, 0xffffffff, 0xffffffff, 0xffffffff, 0xffffffff
.long 0xffffffff, 0xffffffff, 0xffffffff, 0xffffffff, 0xffffffff, 0xffffffff, 0xffffffff, 0xffffffff
.long 0x1848e00, 0x1651500, 0xffffffff, 0xffffffff, 0xffffffff, 0xffffffff, 0xffffffff, 0xffffffff
.long 0x1769900, 0x17d9b00, 0xffffffff, 0xffffffff, 0xffffffff, 0xffffffff, 0xffffffff, 0xffffffff
.long 0x1688d00, 0x1769700, 0xffffffff, 0xffffffff, 0xffffffff, 0xffffffff, 0xffffffff, 0xffffffff
.long 0x17d9800, 0x16f9300, 0xffffffff, 0xffffffff, 0xffffffff, 0xffffffff, 0xffffffff, 0xffffffff
.long 0x16f9400, 0x1688f00, 0xffffffff, 0xffffffff, 0xffffffff, 0xffffffff, 0xffffffff, 0xffffffff
.long 0x1731000, 0xffffffff, 0xffffffff, 0xffffffff, 0xffffffff, 0xffffffff, 0xffffffff, 0xffffffff
.long 0x16c0c00, 0xffffffff, 0xffffffff, 0xffffffff, 0xffffffff, 0xffffffff, 0xffffffff, 0xffffffff
.long 0xffffffff, 0xffffffff, 0xffffffff, 0xffffffff, 0xffffffff, 0xffffffff, 0xffffffff, 0xffffffff
.long 0xe0300, 0xe0e00, 0xffffffff, 0xffffffff, 0xffffffff, 0xffffffff, 0xffffffff, 0xffffffff
.long 0x380d00, 0x3b8800, 0xffffffff, 0xffffffff, 0xffffffff, 0xffffffff, 0xffffffff, 0xffffffff
.long 0x3b9000, 0x1c0300, 0xffffffff, 0xffffffff, 0xffffffff, 0xffffffff, 0xffffffff, 0xffffffff
.long 0x150b00, 0x4d0d00, 0xffffffff, 0xffffffff, 0xffffffff, 0xffffffff, 0xffffffff, 0xffffffff
.long 0x3f0600, 0x1000, 0xffffffff, 0xffffffff, 0xffffffff, 0xffffffff, 0xffffffff, 0xffffffff
.long 0x268000, 0x310b00, 0xffffffff, 0xffffffff, 0xffffffff, 0xffffffff, 0xffffffff, 0xffffffff
.long 0x70500, 0x118600, 0xffffffff, 0xffffffff, 0xffffffff, 0xffffffff, 0xffffffff, 0xffffffff
.long 0xffffffff, 0xffffffff, 0xffffffff, 0xffffffff, 0xffffffff, 0xffffffff, 0xffffffff, 0xffffffff
.long 0x231600, 0x7a8400, 0xffffffff, 0xffffffff, 0xffffffff, 0xffffffff, 0xffffffff, 0xffffffff
.long 0x9d8500, 0x39b00, 0xffffffff, 0xffffffff, 0xffffffff, 0xffffffff, 0xffffffff, 0xffffffff
.long 0x5b0700, 0x311600, 0xffffffff, 0xffffffff, 0xffffffff, 0xffffffff, 0xffffffff, 0xffffffff
.long 0x850200, 0x620500, 0xffffffff, 0xffffffff, 0xffffffff, 0xffffffff, 0xffffffff, 0xffffffff
.long 0x39800, 0x700700, 0xffffffff, 0xffffffff, 0xffffffff, 0xffffffff, 0xffffffff, 0xffffffff
.long 0x3f1300, 0x508200, 0xffffffff, 0xffffffff, 0xffffffff, 0xffffffff, 0xffffffff, 0xffffffff
.long 0x71900, 0x269800, 0xffffffff, 0xffffffff, 0xffffffff, 0xffffffff, 0xffffffff, 0xffffffff
.long 0xffffffff, 0xffffffff, 0xffffffff, 0xffffffff, 0xffffffff, 0xffffffff, 0xffffffff, 0xffffffff
.long 0x5e8b00, 0x5e9600, 0xffffffff, 0xffffffff, 0xffffffff, 0xffffffff, 0xffffffff, 0xffffffff
.long 0x889500, 0x8c1000, 0xffffffff, 0xffffffff, 0xffffffff, 0xffffffff, 0xffffffff, 0xffffffff
.long 0x8c1800, 0x6c8b00, 0xffffffff, 0xffffffff, 0xffffffff, 0xffffffff, 0xffffffff, 0xffffffff
.long 0x659300, 0x9d9500, 0xffffffff, 0xffffffff, 0xffffffff, 0xffffffff, 0xffffffff, 0xffffffff
.long 0x8f8e00, 0x509800, 0xffffffff, 0xffffffff, 0xffffffff, 0xffffffff, 0xffffffff, 0xffffffff
.long 0x770800, 0x819300, 0xffffffff, 0xffffffff, 0xffffffff, 0xffffffff, 0xffffffff, 0xffffffff
.long 0x578d00, 0x620e00, 0xffffffff, 0xffffffff, 0xffffffff, 0xffffffff, 0xffffffff, 0xffffffff
.long 0xffffffff, 0xffffffff, 0xffffffff, 0xffffffff, 0xffffffff, 0xffffffff, 0xffffffff, 0xffffffff
.long 0xcb0200, 0xd58c00, 0xffffffff, 0xffffffff, 0xffffffff, 0xffffffff, 0xffffffff, 0xffffffff
.long 0xdc8d00, 0xb28700, 0xffffffff, 0xffffffff, 0xffffffff, 0xffffffff, 0xffffffff, 0xffffffff
.long 0xb98f00, 0xd90200, 0xffffffff, 0xffffffff, 0xffffffff, 0xffffffff, 0xffffffff, 0xffffffff
.long 0xd90a00, 0xa48d00, 0xffffffff, 0xffffffff, 0xffffffff, 0xffffffff, 0xffffffff, 0xffffffff
.long 0xaf0400, 0xce8f00, 0xffffffff, 0xffffffff, 0xffffffff, 0xffffffff, 0xffffffff, 0xffffffff
.long 0x541b00, 0xa80a00, 0xffffffff, 0xffffffff, 0xffffffff, 0xffffffff, 0xffffffff, 0xffffffff
.long 0xab8500, 0xffffffff, 0xffffffff, 0xffffffff, 0xffffffff, 0xffffffff, 0xffffffff, 0xffffffff
.long 0xffffffff, 0xffffffff, 0xffffffff, 0xffffffff, 0xffffffff, 0xffffffff, 0xffffffff, 0xffffffff
.long 0xea9400, 0x12d0100, 0xffffffff, 0xffffffff, 0xffffffff, 0xffffffff, 0xffffffff, 0xffffffff
.long 0xdc9000, 0xe39100, 0xffffffff, 0xffffffff, 0xffffffff, 0xffffffff, 0xffffffff, 0xffffffff
.long 0xea9500, 0x11b8200, 0xffffffff, 0xffffffff, 0xffffffff, 0xffffffff, 0xffffffff, 0xffffffff
.long 0x1260300, 0xd59a00, 0xffffffff, 0xffffffff, 0xffffffff, 0xffffffff, 0xffffffff, 0xffffffff
.long 0xd59b00, 0xce9600, 0xffffffff, 0xffffffff, 0xffffffff, 0xffffffff, 0xffffffff, 0xffffffff
.long 0xd91700, 0xffffffff, 0xffffffff, 0xffffffff, 0xffffffff, 0xffffffff, 0xffffffff, 0xffffffff
.long 0xd21300, 0xffffffff, 0xffffffff, 0xffffffff, 0xffffffff, 0xffffffff, 0xffffffff, 0xffffffff
.long 0xffffffff, 0xffffffff, 0xffffffff, 0xffffffff, 0xffffffff, 0xffffffff, 0xffffffff, 0xffffffff
.long 0x1068800, 0x1379100, 0xffffffff, 0xffffffff, 0xffffffff, 0xffffffff, 0xffffffff, 0xffffffff
.long 0xf89500, 0x1308500, 0xffffffff, 0xffffffff, 0xffffffff, 0xffffffff, 0xffffffff, 0xffffffff
.long 0x1378900, 0xf89200, 0xffffffff, 0xffffffff, 0xffffffff, 0xffffffff, 0xffffffff, 0xffffffff
.long 0x1031300, 0xf18e00, 0xffffffff, 0xffffffff, 0xffffffff, 0xffffffff, 0xffffffff, 0xffffffff
.long 0xf50f00, 0x1378a00, 0xffffffff, 0xffffffff, 0xffffffff, 0xffffffff, 0xffffffff, 0xffffffff
.long 0xf88b00, 0xffffffff, 0xffffffff, 0xffffffff, 0xffffffff, 0xffffffff, 0xffffffff, 0xffffffff
.long 0xf18700, 0xffffffff, 0xffffffff, 0xffffffff, 0xffffffff, 0xffffffff, 0xffffffff, 0xffffffff
.long 0xffffffff, 0xffffffff, 0xffffffff, 0xffffffff, 0xffffffff, 0xffffffff, 0xffffffff, 0xffffffff
.long 0xfc1a00, 0x1650900, 0xffffffff, 0xffffffff, 0xffffffff, 0xffffffff, 0xffffffff, 0xffffffff
.long 0xee1600, 0x1309900, 0xffffffff, 0xffffffff, 0xffffffff, 0xffffffff, 0xffffffff, 0xffffffff
.long 0x1688100, 0x17d8700, 0xffffffff, 0xffffffff, 0xffffffff, 0xffffffff, 0xffffffff, 0xffffffff
.long 0x13b0800, 0x1768300, 0xffffffff, 0xffffffff, 0xffffffff, 0xffffffff, 0xffffffff, 0xffffffff
.long 0x17a0400, 0x12d1b00, 0xffffffff, 0xffffffff, 0xffffffff, 0xffffffff, 0xffffffff, 0xffffffff
.long 0x17d8000, 0xffffffff, 0xffffffff, 0xffffffff, 0xffffffff, 0xffffffff, 0xffffffff, 0xffffffff
.long 0x1341800, 0xffffffff, 0xffffffff, 0xffffffff, 0xffffffff, 0xffffffff, 0xffffffff, 0xffffffff
.long 0xffffffff, 0xffffffff, 0xffffffff, 0xffffffff, 0xffffffff, 0xffffffff, 0xffffffff, 0xffffffff
.long 0x1538f00, 0x1849900, 0xffffffff, 0xffffffff, 0xffffffff, 0xffffffff, 0xffffffff, 0xffffffff
.long 0x1458b00, 0x17d8d00, 0xffffffff, 0xffffffff, 0xffffffff, 0xffffffff, 0xffffffff, 0xffffffff
.long 0x1849100, 0x1459800, 0xffffffff, 0xffffffff, 0xffffffff, 0xffffffff, 0xffffffff, 0xffffffff
.long 0x1501a00, 0x13e9400, 0xffffffff, 0xffffffff, 0xffffffff, 0xffffffff, 0xffffffff, 0xffffffff
.long 0x1421600, 0x1849000, 0xffffffff, 0xffffffff, 0xffffffff, 0xffffffff, 0xffffffff, 0xffffffff
.long 0x1459200, 0xffffffff, 0xffffffff, 0xffffffff, 0xffffffff, 0xffffffff, 0xffffffff, 0xffffffff
.long 0x13e8e00, 0xffffffff, 0xffffffff, 0xffffffff, 0xffffffff, 0xffffffff, 0xffffffff, 0xffffffff
.long 0xffffffff, 0xffffffff, 0xffffffff, 0xffffffff, 0xffffffff, 0xffffffff, 0xffffffff, 0xffffffff
.long 0x2a0400, 0x2a0f00, 0xffffffff, 0xffffffff, 0xffffffff, 0xffffffff, 0xffffffff, 0xffffffff
.long 0x39100, 0xa8a00, 0xffffffff, 0xffffffff, 0xffffffff, 0xffffffff, 0xffffffff, 0xffffffff
.long 0x2d8100, 0x380400, 0xffffffff, 0xffffffff, 0xffffffff, 0xffffffff, 0xffffffff, 0xffffffff
.long 0x310c00, 0x189100, 0xffffffff, 0xffffffff, 0xffffffff, 0xffffffff, 0xffffffff, 0xffffffff
.long 0xa8700, 0x498100, 0xffffffff, 0xffffffff, 0xffffffff, 0xffffffff, 0xffffffff, 0xffffffff
.long 0x460200, 0x4d0c00, 0xffffffff, 0xffffffff, 0xffffffff, 0xffffffff, 0xffffffff, 0xffffffff
.long 0x230900, 0x2d8700, 0xffffffff, 0xffffffff, 0xffffffff, 0xffffffff, 0xffffffff, 0xffffffff
.long 0xffffffff, 0xffffffff, 0xffffffff, 0xffffffff, 0xffffffff, 0xffffffff, 0xffffffff, 0xffffffff
.long 0x429700, 0x9a0600, 0xffffffff, 0xffffffff, 0xffffffff, 0xffffffff, 0xffffffff, 0xffffffff
.long 0x189200, 0x770000, 0xffffffff, 0xffffffff, 0xffffffff, 0xffffffff, 0xffffffff, 0xffffffff
.long 0x2d9500, 0x1700, 0xffffffff, 0xffffffff, 0xffffffff, 0xffffffff, 0xffffffff, 0xffffffff
.long 0x508300, 0x2d9200, 0xffffffff, 0xffffffff, 0xffffffff, 0xffffffff, 0xffffffff, 0xffffffff
.long 0x1f9a00, 0x499500, 0xffffffff, 0xffffffff, 0xffffffff, 0xffffffff, 0xffffffff, 0xffffffff
.long 0xa9400, 0x6c8300, 0xffffffff, 0xffffffff, 0xffffffff, 0xffffffff, 0xffffffff, 0xffffffff
.long 0x8c0100, 0x429a00, 0xffffffff, 0xffffffff, 0xffffffff, 0xffffffff, 0xffffffff, 0xffffffff
.long 0xffffffff, 0xffffffff, 0xffffffff, 0xffffffff, 0xffffffff, 0xffffffff, 0xffffffff, 0xffffffff
.long 0x7a8c00, 0x7a9700, 0xffffffff, 0xffffffff, 0xffffffff, 0xffffffff, 0xffffffff, 0xffffffff
.long 0x541900, 0x5b1200, 0xffffffff, 0xffffffff, 0xffffffff, 0xffffffff, 0xffffffff, 0xffffffff
.long 0x7e0900, 0x888c00, 0xffffffff, 0xffffffff, 0xffffffff, 0xffffffff, 0xffffffff, 0xffffffff
.long 0x819400, 0x691900, 0xffffffff, 0xffffffff, 0xffffffff, 0xffffffff, 0xffffffff, 0xffffffff
.long 0x5b0f00, 0x9a0900, 0xffffffff, 0xffffffff, 0xffffffff, 0xffffffff, 0xffffffff, 0xffffffff
.long 0x968a00, 0x9d9400, 0xffffffff, 0xffffffff, 0xffffffff, 0xffffffff, 0xffffffff, 0xffffffff
.long 0x739100, 0x7e0f00, 0xffffffff, 0xffffffff, 0xffffffff, 0xffffffff, 0xffffffff, 0xffffffff
.long 0xffffffff, 0xffffffff, 0xffffffff, 0xffffffff, 0xffffffff, 0xffffffff, 0xffffffff, 0xffffffff
.long 0xea8300, 0xa48e00, 0xffffffff, 0xffffffff, 0xffffffff, 0xffffffff, 0xffffffff, 0xffffffff
.long 0x819a00, 0xce8800, 0xffffffff, 0xffffffff, 0xffffffff, 0xffffffff, 0xffffffff, 0xffffffff
.long 0xce8100, 0xab8300, 0xffffffff, 0xffffffff, 0xffffffff, 0xffffffff, 0xffffffff, 0xffffffff
.long 0xab8b00, 0x969a00, 0xffffffff, 0xffffffff, 0xffffffff, 0xffffffff, 0xffffffff, 0xffffffff
.long 0xcb0600, 0xea8100, 0xffffffff, 0xffffffff, 0xffffffff, 0xffffffff, 0xffffffff, 0xffffffff
.long 0xb28000, 0xc78b00, 0xffffffff, 0xffffffff, 0xffffffff, 0xffffffff, 0xffffffff, 0xffffffff
.long 0xc78900, 0xffffffff, 0xffffffff, 0xffffffff, 0xffffffff, 0xffffffff, 0xffffffff, 0xffffffff
.long 0xffffffff, 0xffffffff, 0xffffffff, 0xffffffff, 0xffffffff, 0xffffffff, 0xffffffff, 0xffffffff
.long 0xb99600, 0xea9000, 0xffffffff, 0xffffffff, 0xffffffff, 0xffffffff, 0xffffffff, 0xffffffff
.long 0xab9200, 0xb29500, 0xffffffff, 0xffffffff, 0xffffffff, 0xffffffff, 0xffffffff, 0xffffffff
.long 0xb99900, 0xee0300, 0xffffffff, 0xffffffff, 0xffffffff, 0xffffffff, 0xffffffff, 0xffffffff
.long 0xf50400, 0xa49b00, 0xffffffff, 0xffffffff, 0xffffffff, 0xffffffff, 0xffffffff, 0xffffffff
.long 0x1340000, 0xea9700, 0xffffffff, 0xffffffff, 0xffffffff, 0xffffffff, 0xffffffff, 0xffffffff
.long 0xab9800, 0xffffffff, 0xffffffff, 0xffffffff, 0xffffffff, 0xffffffff, 0xffffffff, 0xffffffff
.long 0xa49400, 0xffffffff, 0xffffffff, 0xffffffff, 0xffffffff, 0xffffffff, 0xffffffff, 0xffffffff
.long 0xffffffff, 0xffffffff, 0xffffffff, 0xffffffff, 0xffffffff, 0xffffffff, 0xffffffff, 0xffffffff
.long 0x1228a00, 0x1069500, 0xffffffff, 0xffffffff, 0xffffffff, 0xffffffff, 0xffffffff, 0xffffffff
.long 0x1148600, 0xff8900, 0xffffffff, 0xffffffff, 0xffffffff, 0xffffffff, 0xffffffff, 0xffffffff
.long 0x1068d00, 0x1181300, 0xffffffff, 0xffffffff, 0xffffffff, 0xffffffff, 0xffffffff, 0xffffffff
.long 0x11f1400, 0x1110f00, 0xffffffff, 0xffffffff, 0xffffffff, 0xffffffff, 0xffffffff, 0xffffffff
.long 0x1111000, 0x10a0b00, 0xffffffff, 0xffffffff, 0xffffffff, 0xffffffff, 0xffffffff, 0xffffffff
.long 0x1148c00, 0xffffffff, 0xffffffff, 0xffffffff, 0xffffffff, 0xffffffff, 0xffffffff, 0xffffffff
.long 0x10d8800, 0xffffffff, 0xffffffff, 0xffffffff, 0xffffffff, 0xffffffff, 0xffffffff, 0xffffffff
.long 0xffffffff, 0xffffffff, 0xffffffff, 0xffffffff, 0xffffffff, 0xffffffff, 0xffffffff, 0xffffffff
.long 0x1181b00, 0xfc1600, 0xffffffff, 0xffffffff, 0xffffffff, 0xffffffff, 0xffffffff, 0xffffffff
.long 0x10a1700, 0x17d8100, 0xffffffff, 0xffffffff, 0xffffffff, 0xffffffff, 0xffffffff, 0xffffffff
.long 0x1848500, 0x1500800, 0xffffffff, 0xffffffff, 0xffffffff, 0xffffffff, 0xffffffff, 0xffffffff
.long 0x1570a00, 0x1490400, 0xffffffff, 0xffffffff, 0xffffffff, 0xffffffff, 0xffffffff, 0xffffffff
.long 0x1490600, 0x1420000, 0xffffffff, 0xffffffff, 0xffffffff, 0xffffffff, 0xffffffff, 0xffffffff
.long 0x14c8200, 0xffffffff, 0xffffffff, 0xffffffff, 0xffffffff, 0xffffffff, 0xffffffff, 0xffffffff
.long 0x1031a00, 0xffffffff, 0xffffffff, 0xffffffff, 0xffffffff, 0xffffffff, 0xffffffff, 0xffffffff
.long 0xffffffff, 0xffffffff, 0xffffffff, 0xffffffff, 0xffffffff, 0xffffffff, 0xffffffff, 0xffffffff
.long 0x16f9000, 0x1538b00, 0xffffffff, 0xffffffff, 0xffffffff, 0xffffffff, 0xffffffff, 0xffffffff
.long 0x1618c00, 0x14c9100, 0xffffffff, 0xffffffff, 0xffffffff, 0xffffffff, 0xffffffff, 0xffffffff
.long 0x1539500, 0x1651a00, 0xffffffff, 0xffffffff, 0xffffffff, 0xffffffff, 0xffffffff, 0xffffffff
.long 0x16c1b00, 0x15e1600, 0xffffffff, 0xffffffff, 0xffffffff, 0xffffffff, 0xffffffff, 0xffffffff
.long 0x15e1700, 0x1571200, 0xffffffff, 0xffffffff, 0xffffffff, 0xffffffff, 0xffffffff, 0xffffffff
.long 0x1619300, 0xffffffff, 0xffffffff, 0xffffffff, 0xffffffff, 0xffffffff, 0xffffffff, 0xffffffff
.long 0x15a8f00, 0xffffffff, 0xffffffff, 0xffffffff, 0xffffffff, 0xffffffff, 0xffffffff, 0xffffffff
.long 0xffffffff, 0xffffffff, 0xffffffff, 0xffffffff, 0xffffffff, 0xffffffff, 0xffffffff, 0xffffffff
.long 0x498600, 0x461000, 0xffffffff, 0xffffffff, 0xffffffff, 0xffffffff, 0xffffffff, 0xffffffff
.long 0x1f8000, 0x268b00, 0xffffffff, 0xffffffff, 0xffffffff, 0xffffffff, 0xffffffff, 0xffffffff
.long 0x498500, 0x70600, 0xffffffff, 0xffffffff, 0xffffffff, 0xffffffff, 0xffffffff, 0xffffffff
.long 0xe00, 0x348000, 0xffffffff, 0xffffffff, 0xffffffff, 0xffffffff, 0xffffffff, 0xffffffff
.long 0x268800, 0x150500, 0xffffffff, 0xffffffff, 0xffffffff, 0xffffffff, 0xffffffff, 0xffffffff
.long 0x118300, 0x1c0e00, 0xffffffff, 0xffffffff, 0xffffffff, 0xffffffff, 0xffffffff, 0xffffffff
.long 0x428d00, 0x498800, 0xffffffff, 0xffffffff, 0xffffffff, 0xffffffff, 0xffffffff, 0xffffffff
.long 0xffffffff, 0xffffffff, 0xffffffff, 0xffffffff, 0xffffffff, 0xffffffff, 0xffffffff, 0xffffffff
.long 0xe1800, 0x658700, 0xffffffff, 0xffffffff, 0xffffffff, 0xffffffff, 0xffffffff, 0xffffffff
.long 0x381300, 0x968200, 0xffffffff, 0xffffffff, 0xffffffff, 0xffffffff, 0xffffffff, 0xffffffff
.long 0x499900, 0x1c1800, 0xffffffff, 0xffffffff, 0xffffffff, 0xffffffff, 0xffffffff, 0xffffffff
.long 0x6c8400, 0x4d1300, 0xffffffff, 0xffffffff, 0xffffffff, 0xffffffff, 0xffffffff, 0xffffffff
.long 0x3f1b00, 0x151900, 0xffffffff, 0xffffffff, 0xffffffff, 0xffffffff, 0xffffffff, 0xffffffff
.long 0x269600, 0x888400, 0xffffffff, 0xffffffff, 0xffffffff, 0xffffffff, 0xffffffff, 0xffffffff
.long 0x578500, 0x119b00, 0xffffffff, 0xffffffff, 0xffffffff, 0xffffffff, 0xffffffff, 0xffffffff
.long 0xffffffff, 0xffffffff, 0xffffffff, 0xffffffff, 0xffffffff, 0xffffffff, 0xffffffff, 0xffffffff
.long 0x9a0e00, 0x969800, 0xffffffff, 0xffffffff, 0xffffffff, 0xffffffff, 0xffffffff, 0xffffffff
.long 0x700800, 0x771300, 0xffffffff, 0xffffffff, 0xffffffff, 0xffffffff, 0xffffffff, 0xffffffff
.long 0x9a0d00, 0x578e00, 0xffffffff, 0xffffffff, 0xffffffff, 0xffffffff, 0xffffffff, 0xffffffff
.long 0x509600, 0x850800, 0xffffffff, 0xffffffff, 0xffffffff, 0xffffffff, 0xffffffff, 0xffffffff
.long 0x771000, 0x658d00, 0xffffffff, 0xffffffff, 0xffffffff, 0xffffffff, 0xffffffff, 0xffffffff
.long 0x620b00, 0x6c9600, 0xffffffff, 0xffffffff, 0xffffffff, 0xffffffff, 0xffffffff, 0xffffffff
.long 0x931500, 0x9a1000, 0xffffffff, 0xffffffff, 0xffffffff, 0xffffffff, 0xffffffff, 0xffffffff
.long 0xffffffff, 0xffffffff, 0xffffffff, 0xffffffff, 0xffffffff, 0xffffffff, 0xffffffff, 0xffffffff
.long 0xb98400, 0xc40f00, 0xffffffff, 0xffffffff, 0xffffffff, 0xffffffff, 0xffffffff, 0xffffffff
.long 0x9d9b00, 0xea8a00, 0xffffffff, 0xffffffff, 0xffffffff, 0xffffffff, 0xffffffff, 0xffffffff
.long 0xea8500, 0xc78400, 0xffffffff, 0xffffffff, 0xffffffff, 0xffffffff, 0xffffffff, 0xffffffff
.long 0xc78c00, 0x621b00, 0xffffffff, 0xffffffff, 0xffffffff, 0xffffffff, 0xffffffff, 0xffffffff
.long 0xea8700, 0xb98500, 0xffffffff, 0xffffffff, 0xffffffff, 0xffffffff, 0xffffffff, 0xffffffff
.long 0xce8200, 0xe38c00, 0xffffffff, 0xffffffff, 0xffffffff, 0xffffffff, 0xffffffff, 0xffffffff
.long 0xe70d00, 0xffffffff, 0xffffffff, 0xffffffff, 0xffffffff, 0xffffffff, 0xffffffff, 0xffffffff
.long 0xffffffff, 0xffffffff, 0xffffffff, 0xffffffff, 0xffffffff, 0xffffffff, 0xffffffff, 0xffffffff
.long 0xd59700, 0xb99200, 0xffffffff, 0xffffffff, 0xffffffff, 0xffffffff, 0xffffffff, 0xffffffff
.long 0xc79300, 0xce9900, 0xffffffff, 0xffffffff, 0xffffffff, 0xffffffff, 0xffffffff, 0xffffffff
.long 0x11b8100, 0x10a0400, 0xffffffff, 0xffffffff, 0xffffffff, 0xffffffff, 0xffffffff, 0xffffffff
.long 0xcb1100, 0x1030000, 0xffffffff, 0xffffffff, 0xffffffff, 0xffffffff, 0xffffffff, 0xffffffff
.long 0x1030200, 0xbd1800, 0xffffffff, 0xffffffff, 0xffffffff, 0xffffffff, 0xffffffff, 0xffffffff
.long 0xc79a00, 0xffffffff, 0xffffffff, 0xffffffff, 0xffffffff, 0xffffffff, 0xffffffff, 0xffffffff
.long 0xc09600, 0xffffffff, 0xffffffff, 0xffffffff, 0xffffffff, 0xffffffff, 0xffffffff, 0xffffffff
.long 0xffffffff, 0xffffffff, 0xffffffff, 0xffffffff, 0xffffffff, 0xffffffff, 0xffffffff, 0xffffffff
.long 0xf50b00, 0x1228600, 0xffffffff, 0xffffffff, 0xffffffff, 0xffffffff, 0xffffffff, 0xffffffff
.long 0x1340700, 0x11b8d00, 0xffffffff, 0xffffffff, 0xffffffff, 0xffffffff, 0xffffffff, 0xffffffff
.long 0x1261100, 0x1341400, 0xffffffff, 0xffffffff, 0xffffffff, 0xffffffff, 0xffffffff, 0xffffffff
.long 0x1180500, 0x12d1000, 0xffffffff, 0xffffffff, 0xffffffff, 0xffffffff, 0xffffffff, 0xffffffff
.long 0x12d1200, 0x1260c00, 0xffffffff, 0xffffffff, 0xffffffff, 0xffffffff, 0xffffffff, 0xffffffff
.long 0x1308e00, 0xffffffff, 0xffffffff, 0xffffffff, 0xffffffff, 0xffffffff, 0xffffffff, 0xffffffff
.long 0x1298a00, 0xffffffff, 0xffffffff, 0xffffffff, 0xffffffff, 0xffffffff, 0xffffffff, 0xffffffff
.long 0xffffffff, 0xffffffff, 0xffffffff, 0xffffffff, 0xffffffff, 0xffffffff, 0xffffffff, 0xffffffff
.long 0x17a0000, 0x1181700, 0xffffffff, 0xffffffff, 0xffffffff, 0xffffffff, 0xffffffff, 0xffffffff
.long 0x1299800, 0x14c8500, 0xffffffff, 0xffffffff, 0xffffffff, 0xffffffff, 0xffffffff, 0xffffffff
.long 0x1538900, 0x16c0a00, 0xffffffff, 0xffffffff, 0xffffffff, 0xffffffff, 0xffffffff, 0xffffffff
.long 0x1181900, 0x1650600, 0xffffffff, 0xffffffff, 0xffffffff, 0xffffffff, 0xffffffff, 0xffffffff
.long 0x1650700, 0x15e0200, 0xffffffff, 0xffffffff, 0xffffffff, 0xffffffff, 0xffffffff, 0xffffffff
.long 0x1688300, 0xffffffff, 0xffffffff, 0xffffffff, 0xffffffff, 0xffffffff, 0xffffffff, 0xffffffff
.long 0x11f1b00, 0xffffffff, 0xffffffff, 0xffffffff, 0xffffffff, 0xffffffff, 0xffffffff, 0xffffffff
.long 0xffffffff, 0xffffffff, 0xffffffff, 0xffffffff, 0xffffffff, 0xffffffff, 0xffffffff, 0xffffffff
.long 0x1421200, 0x16f8c00, 0xffffffff, 0xffffffff, 0xffffffff, 0xffffffff, 0xffffffff, 0xffffffff
.long 0x1810e00, 0x1689500, 0xffffffff, 0xffffffff, 0xffffffff, 0xffffffff, 0xffffffff, 0xffffffff
.long 0x1731900, 0x1811b00, 0xffffffff, 0xffffffff, 0xffffffff, 0xffffffff, 0xffffffff, 0xffffffff
.long 0x1650d00, 0x17a1700, 0xffffffff, 0xffffffff, 0xffffffff, 0xffffffff, 0xffffffff, 0xffffffff
.long 0x17a1800, 0x1731300, 0xffffffff, 0xffffffff, 0xffffffff, 0xffffffff, 0xffffffff, 0xffffffff
.long 0x17d9400, 0xffffffff, 0xffffffff, 0xffffffff, 0xffffffff, 0xffffffff, 0xffffffff, 0xffffffff
.long 0x1769000, 0xffffffff, 0xffffffff, 0xffffffff, 0xffffffff, 0xffffffff, 0xffffffff, 0xffffffff
.long 0xffffffff, 0xffffffff, 0xffffffff, 0xffffffff, 0xffffffff, 0xffffffff, 0xffffffff, 0xffffffff
.long 0x150700, 0x3f0100, 0xffffffff, 0xffffffff, 0xffffffff, 0xffffffff, 0xffffffff, 0xffffffff
.long 0x3f0200, 0x428c00, 0xffffffff, 0xffffffff, 0xffffffff, 0xffffffff, 0xffffffff, 0xffffffff
.long 0x150900, 0x230700, 0xffffffff, 0xffffffff, 0xffffffff, 0xffffffff, 0xffffffff, 0xffffffff
.long 0x1c0f00, 0x38200, 0xffffffff, 0xffffffff, 0xffffffff, 0xffffffff, 0xffffffff, 0xffffffff
.long 0x460a00, 0x310900, 0xffffffff, 0xffffffff, 0xffffffff, 0xffffffff, 0xffffffff, 0xffffffff
.long 0x2d8400, 0x380f00, 0xffffffff, 0xffffffff, 0xffffffff, 0xffffffff, 0xffffffff, 0xffffffff
.long 0xe1100, 0x188a00, 0xffffffff, 0xffffffff, 0xffffffff, 0xffffffff, 0xffffffff, 0xffffffff
.long 0xffffffff, 0xffffffff, 0xffffffff, 0xffffffff, 0xffffffff, 0xffffffff, 0xffffffff, 0xffffffff
.long 0x2a1a00, 0x3f1500, 0xffffffff, 0xffffffff, 0xffffffff, 0xffffffff, 0xffffffff, 0xffffffff
.long 0x39400, 0x620300, 0xffffffff, 0xffffffff, 0xffffffff, 0xffffffff, 0xffffffff, 0xffffffff
.long 0x7e0100, 0x381a00, 0xffffffff, 0xffffffff, 0xffffffff, 0xffffffff, 0xffffffff, 0xffffffff
.long 0x8c0600, 0x189400, 0xffffffff, 0xffffffff, 0xffffffff, 0xffffffff, 0xffffffff, 0xffffffff
.long 0x620000, 0x9a0100, 0xffffffff, 0xffffffff, 0xffffffff, 0xffffffff, 0xffffffff, 0xffffffff
.long 0x461700, 0x578600, 0xffffffff, 0xffffffff, 0xffffffff, 0xffffffff, 0xffffffff, 0xffffffff
.long 0x231200, 0x850000, 0xffffffff, 0xffffffff, 0xffffffff, 0xffffffff, 0xffffffff, 0xffffffff
.long 0xffffffff, 0xffffffff, 0xffffffff, 0xffffffff, 0xffffffff, 0xffffffff, 0xffffffff, 0xffffffff
.long 0x658f00, 0x8f8900, 0xffffffff, 0xffffffff, 0xffffffff, 0xffffffff, 0xffffffff, 0xffffffff
.long 0x8f8a00, 0x931400, 0xffffffff, 0xffffffff, 0xffffffff, 0xffffffff, 0xffffffff, 0xffffffff
.long 0x659100, 0x738f00, 0xffffffff, 0xffffffff, 0xffffffff, 0xffffffff, 0xffffffff, 0xffffffff
.long 0x6c9700, 0x540a00, 0xffffffff, 0xffffffff, 0xffffffff, 0xffffffff, 0xffffffff, 0xffffffff
.long 0x969200, 0x819100, 0xffffffff, 0xffffffff, 0xffffffff, 0xffffffff, 0xffffffff, 0xffffffff
.long 0x7e0c00, 0x889700, 0xffffffff, 0xffffffff, 0xffffffff, 0xffffffff, 0xffffffff, 0xffffffff
.long 0x5e9900, 0x691200, 0xffffffff, 0xffffffff, 0xffffffff, 0xffffffff, 0xffffffff, 0xffffffff
.long 0xffffffff, 0xffffffff, 0xffffffff, 0xffffffff, 0xffffffff, 0xffffffff, 0xffffffff, 0xffffffff
.long 0xd58600, 0xe00100, 0xffffffff, 0xffffffff, 0xffffffff, 0xffffffff, 0xffffffff, 0xffffffff
.long 0xab8000, 0xbd0b00, 0xffffffff, 0xffffffff, 0xffffffff, 0xffffffff, 0xffffffff, 0xffffffff
.long 0xb98900, 0xe38600, 0xffffffff, 0xffffffff, 0xffffffff, 0xffffffff, 0xffffffff, 0xffffffff
.long 0xe38e00, 0xc08000, 0xffffffff, 0xffffffff, 0xffffffff, 0xffffffff, 0xffffffff, 0xffffffff
.long 0xb98800, 0xd58900, 0xffffffff, 0xffffffff, 0xffffffff, 0xffffffff, 0xffffffff, 0xffffffff
.long 0xa10300, 0xb28e00, 0xffffffff, 0xffffffff, 0xffffffff, 0xffffffff, 0xffffffff, 0xffffffff
.long 0x8c1a00, 0xffffffff, 0xffffffff, 0xffffffff, 0xffffffff, 0xffffffff, 0xffffffff, 0xffffffff
.long 0xffffffff, 0xffffffff, 0xffffffff, 0xffffffff, 0xffffffff, 0xffffffff, 0xffffffff, 0xffffffff
.long 0xa81800, 0xd59300, 0xffffffff, 0xffffffff, 0xffffffff, 0xffffffff, 0xffffffff, 0xffffffff
.long 0xe71400, 0x1308100, 0xffffffff, 0xffffffff, 0xffffffff, 0xffffffff, 0xffffffff, 0xffffffff
.long 0xd91000, 0xe71100, 0xffffffff, 0xffffffff, 0xffffffff, 0xffffffff, 0xffffffff, 0xffffffff
.long 0xe71500, 0x11f0200, 0xffffffff, 0xffffffff, 0xffffffff, 0xffffffff, 0xffffffff, 0xffffffff
.long 0x1228300, 0xd91a00, 0xffffffff, 0xffffffff, 0xffffffff, 0xffffffff, 0xffffffff, 0xffffffff
.long 0xe39b00, 0xffffffff, 0xffffffff, 0xffffffff, 0xffffffff, 0xffffffff, 0xffffffff, 0xffffffff
.long 0xdc9700, 0xffffffff, 0xffffffff, 0xffffffff, 0xffffffff, 0xffffffff, 0xffffffff, 0xffffffff
.long 0xffffffff, 0xffffffff, 0xffffffff, 0xffffffff, 0xffffffff, 0xffffffff, 0xffffffff, 0xffffffff
.long 0x1110c00, 0xf50700, 0xffffffff, 0xffffffff, 0xffffffff, 0xffffffff, 0xffffffff, 0xffffffff
.long 0x1030800, 0xee1100, 0xffffffff, 0xffffffff, 0xffffffff, 0xffffffff, 0xffffffff, 0xffffffff
.long 0xf51500, 0x1340500, 0xffffffff, 0xffffffff, 0xffffffff, 0xffffffff, 0xffffffff, 0xffffffff
.long 0x1340900, 0xfc1200, 0xffffffff, 0xffffffff, 0xffffffff, 0xffffffff, 0xffffffff, 0xffffffff
.long 0xff9300, 0xf50e00, 0xffffffff, 0xffffffff, 0xffffffff, 0xffffffff, 0xffffffff, 0xffffffff
.long 0x1030f00, 0xffffffff, 0xffffffff, 0xffffffff, 0xffffffff, 0xffffffff, 0xffffffff, 0xffffffff
.long 0xfc0b00, 0xffffffff, 0xffffffff, 0xffffffff, 0xffffffff, 0xffffffff, 0xffffffff, 0xffffffff
.long 0xffffffff, 0xffffffff, 0xffffffff, 0xffffffff, 0xffffffff, 0xffffffff, 0xffffffff, 0xffffffff
.long 0x1490200, 0x1379800, 0xffffffff, 0xffffffff, 0xffffffff, 0xffffffff, 0xffffffff, 0xffffffff
.long 0xf89a00, 0x1688900, 0xffffffff, 0xffffffff, 0xffffffff, 0xffffffff, 0xffffffff, 0xffffffff
.long 0x1379600, 0x1341900, 0xffffffff, 0xffffffff, 0xffffffff, 0xffffffff, 0xffffffff, 0xffffffff
.long 0x1650100, 0x1810700, 0xffffffff, 0xffffffff, 0xffffffff, 0xffffffff, 0xffffffff, 0xffffffff
.long 0x1848800, 0x17a0300, 0xffffffff, 0xffffffff, 0xffffffff, 0xffffffff, 0xffffffff, 0xffffffff
.long 0x13b0400, 0xffffffff, 0xffffffff, 0xffffffff, 0xffffffff, 0xffffffff, 0xffffffff, 0xffffffff
.long 0x1810000, 0xffffffff, 0xffffffff, 0xffffffff, 0xffffffff, 0xffffffff, 0xffffffff, 0xffffffff
.long 0xffffffff, 0xffffffff, 0xffffffff, 0xffffffff, 0xffffffff, 0xffffffff, 0xffffffff, 0xffffffff
.long 0x15e1300, 0x1420e00, 0xffffffff, 0xffffffff, 0xffffffff, 0xffffffff, 0xffffffff, 0xffffffff
.long 0x1500f00, 0x13b1900, 0xffffffff, 0xffffffff, 0xffffffff, 0xffffffff, 0xffffffff, 0xffffffff
.long 0x1420b00, 0x1810d00, 0xffffffff, 0xffffffff, 0xffffffff, 0xffffffff, 0xffffffff, 0xffffffff
.long 0x1811100, 0x1491800, 0xffffffff, 0xffffffff, 0xffffffff, 0xffffffff, 0xffffffff, 0xffffffff
.long 0x14c9a00, 0x1421400, 0xffffffff, 0xffffffff, 0xffffffff, 0xffffffff, 0xffffffff, 0xffffffff
.long 0x1501600, 0xffffffff, 0xffffffff, 0xffffffff, 0xffffffff, 0xffffffff, 0xffffffff, 0xffffffff
.long 0x1491200, 0xffffffff, 0xffffffff, 0xffffffff, 0xffffffff, 0xffffffff, 0xffffffff, 0xffffffff
.long 0xffffffff, 0xffffffff, 0xffffffff, 0xffffffff, 0xffffffff, 0xffffffff, 0xffffffff, 0xffffffff
.long 0x310800, 0xa8500, 0xffffffff, 0xffffffff, 0xffffffff, 0xffffffff, 0xffffffff, 0xffffffff
.long 0xa8300, 0x118e00, 0xffffffff, 0xffffffff, 0xffffffff, 0xffffffff, 0xffffffff, 0xffffffff
.long 0x348d00, 0x3f0800, 0xffffffff, 0xffffffff, 0xffffffff, 0xffffffff, 0xffffffff, 0xffffffff
.long 0x381000, 0x1f8300, 0xffffffff, 0xffffffff, 0xffffffff, 0xffffffff, 0xffffffff, 0xffffffff
.long 0x118b00, 0xd00, 0xffffffff, 0xffffffff, 0xffffffff, 0xffffffff, 0xffffffff, 0xffffffff
.long 0x4d0600, 0x39000, 0xffffffff, 0xffffffff, 0xffffffff, 0xffffffff, 0xffffffff, 0xffffffff
.long 0x2a0000, 0x348b00, 0xffffffff, 0xffffffff, 0xffffffff, 0xffffffff, 0xffffffff, 0xffffffff
.long 0xffffffff, 0xffffffff, 0xffffffff, 0xffffffff, 0xffffffff, 0xffffffff, 0xffffffff, 0xffffffff
.long 0x499b00, 0xa9900, 0xffffffff, 0xffffffff, 0xffffffff, 0xffffffff, 0xffffffff, 0xffffffff
.long 0x1f9600, 0x7e0400, 0xffffffff, 0xffffffff, 0xffffffff, 0xffffffff, 0xffffffff, 0xffffffff
.long 0x9a0500, 0x71b00, 0xffffffff, 0xffffffff, 0xffffffff, 0xffffffff, 0xffffffff, 0xffffffff
.long 0x578700, 0x349600, 0xffffffff, 0xffffffff, 0xffffffff, 0xffffffff, 0xffffffff, 0xffffffff
.long 0x818200, 0x658500, 0xffffffff, 0xffffffff, 0xffffffff, 0xffffffff, 0xffffffff, 0xffffffff
.long 0x119800, 0x738700, 0xffffffff, 0xffffffff, 0xffffffff, 0xffffffff, 0xffffffff, 0xffffffff
.long 0x429300, 0x540200, 0xffffffff, 0xffffffff, 0xffffffff, 0xffffffff, 0xffffffff, 0xffffffff
.long 0xffffffff, 0xffffffff, 0xffffffff, 0xffffffff, 0xffffffff, 0xffffffff, 0xffffffff, 0xffffffff
.long 0x819000, 0x5b0d00, 0xffffffff, 0xffffffff, 0xffffffff, 0xffffffff, 0xffffffff, 0xffffffff
.long 0x5b0b00, 0x621600, 0xffffffff, 0xffffffff, 0xffffffff, 0xffffffff, 0xffffffff, 0xffffffff
.long 0x851500, 0x8f9000, 0xffffffff, 0xffffffff, 0xffffffff, 0xffffffff, 0xffffffff, 0xffffffff
.long 0x889800, 0x700b00, 0xffffffff, 0xffffffff, 0xffffffff, 0xffffffff, 0xffffffff, 0xffffffff
.long 0x621300, 0x509500, 0xffffffff, 0xffffffff, 0xffffffff, 0xffffffff, 0xffffffff, 0xffffffff
.long 0x9d8e00, 0x541800, 0xffffffff, 0xffffffff, 0xffffffff, 0xffffffff, 0xffffffff, 0xffffffff
.long 0x7a8800, 0x851300, 0xffffffff, 0xffffffff, 0xffffffff, 0xffffffff, 0xffffffff, 0xffffffff
.long 0xffffffff, 0xffffffff, 0xffffffff, 0xffffffff, 0xffffffff, 0xffffffff, 0xffffffff, 0xffffffff
.long 0xa80700, 0xaf0500, 0xffffffff, 0xffffffff, 0xffffffff, 0xffffffff, 0xffffffff, 0xffffffff
.long 0xc78200, 0xd90c00, 0xffffffff, 0xffffffff, 0xffffffff, 0xffffffff, 0xffffffff, 0xffffffff
.long 0xd90d00, 0xb60700, 0xffffffff, 0xffffffff, 0xffffffff, 0xffffffff, 0xffffffff, 0xffffffff
.long 0xb60f00, 0xdc8200, 0xffffffff, 0xffffffff, 0xffffffff, 0xffffffff, 0xffffffff, 0xffffffff
.long 0xd58a00, 0xa80d00, 0xffffffff, 0xffffffff, 0xffffffff, 0xffffffff, 0xffffffff, 0xffffffff
.long 0xbd0400, 0xd20f00, 0xffffffff, 0xffffffff, 0xffffffff, 0xffffffff, 0xffffffff, 0xffffffff
.long 0x579b00, 0xffffffff, 0xffffffff, 0xffffffff, 0xffffffff, 0xffffffff, 0xffffffff, 0xffffffff
.long 0xffffffff, 0xffffffff, 0xffffffff, 0xffffffff, 0xffffffff, 0xffffffff, 0xffffffff, 0xffffffff
.long 0xc41a00, 0xa81400, 0xffffffff, 0xffffffff, 0xffffffff, 0xffffffff, 0xffffffff, 0xffffffff
.long 0xb61600, 0xa11000, 0xffffffff, 0xffffffff, 0xffffffff, 0xffffffff, 0xffffffff, 0xffffffff
.long 0xa81200, 0xb61500, 0xffffffff, 0xffffffff, 0xffffffff, 0xffffffff, 0xffffffff, 0xffffffff
.long 0xb61900, 0xf18300, 0xffffffff, 0xffffffff, 0xffffffff, 0xffffffff, 0xffffffff, 0xffffffff
.long 0xf18400, 0xa81b00, 0xffffffff, 0xffffffff, 0xffffffff, 0xffffffff, 0xffffffff, 0xffffffff
.long 0xf50000, 0xffffffff, 0xffffffff, 0xffffffff, 0xffffffff, 0xffffffff, 0xffffffff, 0xffffffff
.long 0xaf1800, 0xffffffff, 0xffffffff, 0xffffffff, 0xffffffff, 0xffffffff, 0xffffffff, 0xffffffff
.long 0xffffffff, 0xffffffff, 0xffffffff, 0xffffffff, 0xffffffff, 0xffffffff, 0xffffffff, 0xffffffff
.long 0x12d0e00, 0x1110800, 0xffffffff, 0xffffffff, 0xffffffff, 0xffffffff, 0xffffffff, 0xffffffff
.long 0x11f0a00, 0x10a1500, 0xffffffff, 0xffffffff, 0xffffffff, 0xffffffff, 0xffffffff, 0xffffffff
.long 0x1110600, 0x1030900, 0xffffffff, 0xffffffff, 0xffffffff, 0xffffffff, 0xffffffff, 0xffffffff
.long 0x1030d00, 0x11b9300, 0xffffffff, 0xffffffff, 0xffffffff, 0xffffffff, 0xffffffff, 0xffffffff
.long 0x11b9400, 0x1148f00, 0xffffffff, 0xffffffff, 0xffffffff, 0xffffffff, 0xffffffff, 0xffffffff
.long 0x11f1000, 0xffffffff, 0xffffffff, 0xffffffff, 0xffffffff, 0xffffffff, 0xffffffff, 0xffffffff
.long 0x1180c00, 0xffffffff, 0xffffffff, 0xffffffff, 0xffffffff, 0xffffffff, 0xffffffff, 0xffffffff
.long 0xffffffff, 0xffffffff, 0xffffffff, 0xffffffff, 0xffffffff, 0xffffffff, 0xffffffff, 0xffffffff
.long 0x1650300, 0x1069a00, 0xffffffff, 0xffffffff, 0xffffffff, 0xffffffff, 0xffffffff, 0xffffffff
.long 0x1149b00, 0xff9600, 0xffffffff, 0xffffffff, 0xffffffff, 0xffffffff, 0xffffffff, 0xffffffff
.long 0x1069700, 0x1810100, 0xffffffff, 0xffffffff, 0xffffffff, 0xffffffff, 0xffffffff, 0xffffffff
.long 0x1810500, 0x1538800, 0xffffffff, 0xffffffff, 0xffffffff, 0xffffffff, 0xffffffff, 0xffffffff
.long 0x1538a00, 0x14c8400, 0xffffffff, 0xffffffff, 0xffffffff, 0xffffffff, 0xffffffff, 0xffffffff
.long 0x1570600, 0xffffffff, 0xffffffff, 0xffffffff, 0xffffffff, 0xffffffff, 0xffffffff, 0xffffffff
.long 0x1500200, 0xffffffff, 0xffffffff, 0xffffffff, 0xffffffff, 0xffffffff, 0xffffffff, 0xffffffff
.long 0xffffffff, 0xffffffff, 0xffffffff, 0xffffffff, 0xffffffff, 0xffffffff, 0xffffffff, 0xffffffff
.long 0x17a1400, 0x15e0f00, 0xffffffff, 0xffffffff, 0xffffffff, 0xffffffff, 0xffffffff, 0xffffffff
.long 0x16c1000, 0x1570b00, 0xffffffff, 0xffffffff, 0xffffffff, 0xffffffff, 0xffffffff, 0xffffffff
.long 0x15e0c00, 0x1501100, 0xffffffff, 0xffffffff, 0xffffffff, 0xffffffff, 0xffffffff, 0xffffffff
.long 0x1501500, 0x1689a00, 0xffffffff, 0xffffffff, 0xffffffff, 0xffffffff, 0xffffffff, 0xffffffff
.long 0x1689b00, 0x1619600, 0xffffffff, 0xffffffff, 0xffffffff, 0xffffffff, 0xffffffff, 0xffffffff
.long 0x16c1700, 0xffffffff, 0xffffffff, 0xffffffff, 0xffffffff, 0xffffffff, 0xffffffff, 0xffffffff
.long 0x1651300, 0xffffffff, 0xffffffff, 0xffffffff, 0xffffffff, 0xffffffff, 0xffffffff, 0xffffffff
.long 0xffffffff, 0xffffffff, 0xffffffff, 0xffffffff, 0xffffffff, 0xffffffff, 0xffffffff, 0xffffffff
.long 0xa00, 0x268900, 0xffffffff, 0xffffffff, 0xffffffff, 0xffffffff, 0xffffffff, 0xffffffff
.long 0x268400, 0x2d8f00, 0xffffffff, 0xffffffff, 0xffffffff, 0xffffffff, 0xffffffff, 0xffffffff
.long 0x1100, 0xe0a00, 0xffffffff, 0xffffffff, 0xffffffff, 0xffffffff, 0xffffffff, 0xffffffff
.long 0x2a0100, 0x3b8400, 0xffffffff, 0xffffffff, 0xffffffff, 0xffffffff, 0xffffffff, 0xffffffff
.long 0x2d8c00, 0x1c1100, 0xffffffff, 0xffffffff, 0xffffffff, 0xffffffff, 0xffffffff, 0xffffffff
.long 0x188700, 0x4d0100, 0xffffffff, 0xffffffff, 0xffffffff, 0xffffffff, 0xffffffff, 0xffffffff
.long 0x498200, 0xc00, 0xffffffff, 0xffffffff, 0xffffffff, 0xffffffff, 0xffffffff, 0xffffffff
.long 0xffffffff, 0xffffffff, 0xffffffff, 0xffffffff, 0xffffffff, 0xffffffff, 0xffffffff, 0xffffffff
.long 0x6c8000, 0x8f8100, 0xffffffff, 0xffffffff, 0xffffffff, 0xffffffff, 0xffffffff, 0xffffffff
.long 0x3f1700, 0x9d8600, 0xffffffff, 0xffffffff, 0xffffffff, 0xffffffff, 0xffffffff, 0xffffffff
.long 0x151200, 0x7a8000, 0xffffffff, 0xffffffff, 0xffffffff, 0xffffffff, 0xffffffff, 0xffffffff
.long 0x2a1500, 0x39700, 0xffffffff, 0xffffffff, 0xffffffff, 0xffffffff, 0xffffffff, 0xffffffff
.long 0x9d8300, 0x311200, 0xffffffff, 0xffffffff, 0xffffffff, 0xffffffff, 0xffffffff, 0xffffffff
.long 0x2d9a00, 0x4d1500, 0xffffffff, 0xffffffff, 0xffffffff, 0xffffffff, 0xffffffff, 0xffffffff
.long 0xe1400, 0x700300, 0xffffffff, 0xffffffff, 0xffffffff, 0xffffffff, 0xffffffff, 0xffffffff
.long 0xffffffff, 0xffffffff, 0xffffffff, 0xffffffff, 0xffffffff, 0xffffffff, 0xffffffff, 0xffffffff
.long 0x509200, 0x771100, 0xffffffff, 0xffffffff, 0xffffffff, 0xffffffff, 0xffffffff, 0xffffffff
.long 0x770c00, 0x7e1700, 0xffffffff, 0xffffffff, 0xffffffff, 0xffffffff, 0xffffffff, 0xffffffff
.long 0x509900, 0x5e9200, 0xffffffff, 0xffffffff, 0xffffffff, 0xffffffff, 0xffffffff, 0xffffffff
.long 0x7a8900, 0x8c0c00, 0xffffffff, 0xffffffff, 0xffffffff, 0xffffffff, 0xffffffff, 0xffffffff
.long 0x7e1400, 0x6c9900, 0xffffffff, 0xffffffff, 0xffffffff, 0xffffffff, 0xffffffff, 0xffffffff
.long 0x690f00, 0x9d8900, 0xffffffff, 0xffffffff, 0xffffffff, 0xffffffff, 0xffffffff, 0xffffffff
.long 0x9a0a00, 0x509400, 0xffffffff, 0xffffffff, 0xffffffff, 0xffffffff, 0xffffffff, 0xffffffff
.long 0xffffffff, 0xffffffff, 0xffffffff, 0xffffffff, 0xffffffff, 0xffffffff, 0xffffffff, 0xffffffff
.long 0xc40800, 0xcb0900, 0xffffffff, 0xffffffff, 0xffffffff, 0xffffffff, 0xffffffff, 0xffffffff
.long 0xe70300, 0xa80e00, 0xffffffff, 0xffffffff, 0xffffffff, 0xffffffff, 0xffffffff, 0xffffffff
.long 0x7e1a00, 0xd20800, 0xffffffff, 0xffffffff, 0xffffffff, 0xffffffff, 0xffffffff, 0xffffffff
.long 0xcb0100, 0xaf0300, 0xffffffff, 0xffffffff, 0xffffffff, 0xffffffff, 0xffffffff, 0xffffffff
.long 0xa80b00, 0x9a1a00, 0xffffffff, 0xffffffff, 0xffffffff, 0xffffffff, 0xffffffff, 0xffffffff
.long 0xd90600, 0x9d9a00, 0xffffffff, 0xffffffff, 0xffffffff, 0xffffffff, 0xffffffff, 0xffffffff
.long 0xb60000, 0xffffffff, 0xffffffff, 0xffffffff, 0xffffffff, 0xffffffff, 0xffffffff, 0xffffffff
.long 0xffffffff, 0xffffffff, 0xffffffff, 0xffffffff, 0xffffffff, 0xffffffff, 0xffffffff, 0xffffffff
.long 0xe01b00, 0xc41600, 0xffffffff, 0xffffffff, 0xffffffff, 0xffffffff, 0xffffffff, 0xffffffff
.long 0xd21700, 0xbd1200, 0xffffffff, 0xffffffff, 0xffffffff, 0xffffffff, 0xffffffff, 0xffffffff
.long 0xc41300, 0xd21900, 0xffffffff, 0xffffffff, 0xffffffff, 0xffffffff, 0xffffffff, 0xffffffff
.long 0x1180100, 0x10d8400, 0xffffffff, 0xffffffff, 0xffffffff, 0xffffffff, 0xffffffff, 0xffffffff
.long 0xd91100, 0x1068000, 0xffffffff, 0xffffffff, 0xffffffff, 0xffffffff, 0xffffffff, 0xffffffff
.long 0x1110200, 0xffffffff, 0xffffffff, 0xffffffff, 0xffffffff, 0xffffffff, 0xffffffff, 0xffffffff
.long 0xcb1a00, 0xffffffff, 0xffffffff, 0xffffffff, 0xffffffff, 0xffffffff, 0xffffffff, 0xffffffff
.long 0xffffffff, 0xffffffff, 0xffffffff, 0xffffffff, 0xffffffff, 0xffffffff, 0xffffffff, 0xffffffff
.long 0xff8f00, 0x12d0a00, 0xffffffff, 0xffffffff, 0xffffffff, 0xffffffff, 0xffffffff, 0xffffffff
.long 0xf18b00, 0x1260600, 0xffffffff, 0xffffffff, 0xffffffff, 0xffffffff, 0xffffffff, 0xffffffff
.long 0x1308700, 0x11f0d00, 0xffffffff, 0xffffffff, 0xffffffff, 0xffffffff, 0xffffffff, 0xffffffff
.long 0x1229100, 0x1379400, 0xffffffff, 0xffffffff, 0xffffffff, 0xffffffff, 0xffffffff, 0xffffffff
.long 0x1260500, 0x1309000, 0xffffffff, 0xffffffff, 0xffffffff, 0xffffffff, 0xffffffff, 0xffffffff
.long 0xee1200, 0xffffffff, 0xffffffff, 0xffffffff, 0xffffffff, 0xffffffff, 0xffffffff, 0xffffffff
.long 0x1340e00, 0xffffffff, 0xffffffff, 0xffffffff, 0xffffffff, 0xffffffff, 0xffffffff, 0xffffffff
.long 0xffffffff, 0xffffffff, 0xffffffff, 0xffffffff, 0xffffffff, 0xffffffff, 0xffffffff, 0xffffffff
.long 0x1848400, 0x1229b00, 0xffffffff, 0xffffffff, 0xffffffff, 0xffffffff, 0xffffffff, 0xffffffff
.long 0x1768000, 0x11b9700, 0xffffffff, 0xffffffff, 0xffffffff, 0xffffffff, 0xffffffff, 0xffffffff
.long 0x1261800, 0x1500500, 0xffffffff, 0xffffffff, 0xffffffff, 0xffffffff, 0xffffffff, 0xffffffff
.long 0x1500900, 0x16f8a00, 0xffffffff, 0xffffffff, 0xffffffff, 0xffffffff, 0xffffffff, 0xffffffff
.long 0x1261900, 0x1688600, 0xffffffff, 0xffffffff, 0xffffffff, 0xffffffff, 0xffffffff, 0xffffffff
.long 0x1730700, 0xffffffff, 0xffffffff, 0xffffffff, 0xffffffff, 0xffffffff, 0xffffffff, 0xffffffff
.long 0x16c0300, 0xffffffff, 0xffffffff, 0xffffffff, 0xffffffff, 0xffffffff, 0xffffffff, 0xffffffff
.long 0xffffffff, 0xffffffff, 0xffffffff, 0xffffffff, 0xffffffff, 0xffffffff, 0xffffffff, 0xffffffff
.long 0x14c9600, 0x17a1000, 0xffffffff, 0xffffffff, 0xffffffff, 0xffffffff, 0xffffffff, 0xffffffff
.long 0x13e9200, 0x1730c00, 0xffffffff, 0xffffffff, 0xffffffff, 0xffffffff, 0xffffffff, 0xffffffff
.long 0x17d8e00, 0x16c1500, 0xffffffff, 0xffffffff, 0xffffffff, 0xffffffff, 0xffffffff, 0xffffffff
.long 0x16f9900, 0x1849b00, 0xffffffff, 0xffffffff, 0xffffffff, 0xffffffff, 0xffffffff, 0xffffffff
.long 0x1730d00, 0x17d9700, 0xffffffff, 0xffffffff, 0xffffffff, 0xffffffff, 0xffffffff, 0xffffffff
.long 0x13b1800, 0xffffffff, 0xffffffff, 0xffffffff, 0xffffffff, 0xffffffff, 0xffffffff, 0xffffffff
.long 0x1811400, 0xffffffff, 0xffffffff, 0xffffffff, 0xffffffff, 0xffffffff, 0xffffffff, 0xffffffff
.long 0xffffffff, 0xffffffff, 0xffffffff, 0xffffffff, 0xffffffff, 0xffffffff, 0xffffffff, 0xffffffff
.long 0x1c0b00, 0x460d00, 0xffffffff, 0xffffffff, 0xffffffff, 0xffffffff, 0xffffffff, 0xffffffff
.long 0x460600, 0x499000, 0xffffffff, 0xffffffff, 0xffffffff, 0xffffffff, 0xffffffff, 0xffffffff
.long 0x1c0000, 0x2a0b00, 0xffffffff, 0xffffffff, 0xffffffff, 0xffffffff, 0xffffffff, 0xffffffff
.long 0x460500, 0xa8600, 0xffffffff, 0xffffffff, 0xffffffff, 0xffffffff, 0xffffffff, 0xffffffff
.long 0x4d0e00, 0x380000, 0xffffffff, 0xffffffff, 0xffffffff, 0xffffffff, 0xffffffff, 0xffffffff
.long 0x348800, 0x188500, 0xffffffff, 0xffffffff, 0xffffffff, 0xffffffff, 0xffffffff, 0xffffffff
.long 0x150300, 0x1f8e00, 0xffffffff, 0xffffffff, 0xffffffff, 0xffffffff, 0xffffffff, 0xffffffff
.long 0xffffffff, 0xffffffff, 0xffffffff, 0xffffffff, 0xffffffff, 0xffffffff, 0xffffffff, 0xffffffff
.long 0x8c0200, 0x5b0500, 0xffffffff, 0xffffffff, 0xffffffff, 0xffffffff, 0xffffffff, 0xffffffff
.long 0xa9800, 0x690700, 0xffffffff, 0xffffffff, 0xffffffff, 0xffffffff, 0xffffffff, 0xffffffff
.long 0x349300, 0x9a0200, 0xffffffff, 0xffffffff, 0xffffffff, 0xffffffff, 0xffffffff, 0xffffffff
.long 0x461900, 0x1f9800, 0xffffffff, 0xffffffff, 0xffffffff, 0xffffffff, 0xffffffff, 0xffffffff
.long 0x690400, 0x1300, 0xffffffff, 0xffffffff, 0xffffffff, 0xffffffff, 0xffffffff, 0xffffffff
.long 0x4d1b00, 0x189900, 0xffffffff, 0xffffffff, 0xffffffff, 0xffffffff, 0xffffffff, 0xffffffff
.long 0x2a1600, 0x8c0400, 0xffffffff, 0xffffffff, 0xffffffff, 0xffffffff, 0xffffffff, 0xffffffff
.long 0xffffffff, 0xffffffff, 0xffffffff, 0xffffffff, 0xffffffff, 0xffffffff, 0xffffffff, 0xffffffff
.long 0x6c9300, 0x969500, 0xffffffff, 0xffffffff, 0xffffffff, 0xffffffff, 0xffffffff, 0xffffffff
.long 0x968e00, 0x9a1800, 0xffffffff, 0xffffffff, 0xffffffff, 0xffffffff, 0xffffffff, 0xffffffff
.long 0x6c8800, 0x7a9300, 0xffffffff, 0xffffffff, 0xffffffff, 0xffffffff, 0xffffffff, 0xffffffff
.long 0x968d00, 0x5b0e00, 0xffffffff, 0xffffffff, 0xffffffff, 0xffffffff, 0xffffffff, 0xffffffff
.long 0x9d9600, 0x888800, 0xffffffff, 0xffffffff, 0xffffffff, 0xffffffff, 0xffffffff, 0xffffffff
.long 0x851000, 0x690d00, 0xffffffff, 0xffffffff, 0xffffffff, 0xffffffff, 0xffffffff, 0xffffffff
.long 0x658b00, 0x701600, 0xffffffff, 0xffffffff, 0xffffffff, 0xffffffff, 0xffffffff, 0xffffffff
.long 0xffffffff, 0xffffffff, 0xffffffff, 0xffffffff, 0xffffffff, 0xffffffff, 0xffffffff, 0xffffffff
.long 0xe00a00, 0xea8d00, 0xffffffff, 0xffffffff, 0xffffffff, 0xffffffff, 0xffffffff, 0xffffffff
.long 0xb60400, 0xc78f00, 0xffffffff, 0xffffffff, 0xffffffff, 0xffffffff, 0xffffffff, 0xffffffff
.long 0x9a1b00, 0xa10a00, 0xffffffff, 0xffffffff, 0xffffffff, 0xffffffff, 0xffffffff, 0xffffffff
.long 0xe70500, 0xcb0400, 0xffffffff, 0xffffffff, 0xffffffff, 0xffffffff, 0xffffffff, 0xffffffff
.long 0xc40c00, 0x659b00, 0xffffffff, 0xffffffff, 0xffffffff, 0xffffffff, 0xffffffff, 0xffffffff
.long 0xab8700, 0x691b00, 0xffffffff, 0xffffffff, 0xffffffff, 0xffffffff, 0xffffffff, 0xffffffff
.long 0xd20200, 0xffffffff, 0xffffffff, 0xffffffff, 0xffffffff, 0xffffffff, 0xffffffff, 0xffffffff
.long 0xffffffff, 0xffffffff, 0xffffffff, 0xffffffff, 0xffffffff, 0xffffffff, 0xffffffff, 0xffffffff
.long 0xf18000, 0xe01700, 0xffffffff, 0xffffffff, 0xffffffff, 0xffffffff, 0xffffffff, 0xffffffff
.long 0xa49800, 0xd91300, 0xffffffff, 0xffffffff, 0xffffffff, 0xffffffff, 0xffffffff, 0xffffffff
.long 0xe39400, 0x1340100, 0xffffffff, 0xffffffff, 0xffffffff, 0xffffffff, 0xffffffff, 0xffffffff
.long 0xd59000, 0xea9100, 0xffffffff, 0xffffffff, 0xffffffff, 0xffffffff, 0xffffffff, 0xffffffff
.long 0xa81500, 0x1228200, 0xffffffff, 0xffffffff, 0xffffffff, 0xffffffff, 0xffffffff, 0xffffffff
.long 0x1308300, 0xffffffff, 0xffffffff, 0xffffffff, 0xffffffff, 0xffffffff, 0xffffffff, 0xffffffff
.long 0xe71b00, 0xffffffff, 0xffffffff, 0xffffffff, 0xffffffff, 0xffffffff, 0xffffffff, 0xffffffff
.long 0xffffffff, 0xffffffff, 0xffffffff, 0xffffffff, 0xffffffff, 0xffffffff, 0xffffffff, 0xffffffff
.long 0x11b9000, 0xff8b00, 0xffffffff, 0xffffffff, 0xffffffff, 0xffffffff, 0xffffffff, 0xffffffff
.long 0x10d8c00, 0xf88700, 0xffffffff, 0xffffffff, 0xffffffff, 0xffffffff, 0xffffffff, 0xffffffff
.long 0xff8800, 0xf19100, 0xffffffff, 0xffffffff, 0xffffffff, 0xffffffff, 0xffffffff, 0xffffffff
.long 0xf19500, 0x1378500, 0xffffffff, 0xffffffff, 0xffffffff, 0xffffffff, 0xffffffff, 0xffffffff
.long 0xf50900, 0xff9200, 0xffffffff, 0xffffffff, 0xffffffff, 0xffffffff, 0xffffffff, 0xffffffff
.long 0x10d9300, 0xffffffff, 0xffffffff, 0xffffffff, 0xffffffff, 0xffffffff, 0xffffffff, 0xffffffff
.long 0x1068f00, 0xffffffff, 0xffffffff, 0xffffffff, 0xffffffff, 0xffffffff, 0xffffffff, 0xffffffff
.long 0xffffffff, 0xffffffff, 0xffffffff, 0xffffffff, 0xffffffff, 0xffffffff, 0xffffffff, 0xffffffff
.long 0x1538600, 0x1848000, 0xffffffff, 0xffffffff, 0xffffffff, 0xffffffff, 0xffffffff, 0xffffffff
.long 0x1458200, 0xee1800, 0xffffffff, 0xffffffff, 0xffffffff, 0xffffffff, 0xffffffff, 0xffffffff
.long 0xf51a00, 0x16c0900, 0xffffffff, 0xffffffff, 0xffffffff, 0xffffffff, 0xffffffff, 0xffffffff
.long 0x1341600, 0x1379900, 0xffffffff, 0xffffffff, 0xffffffff, 0xffffffff, 0xffffffff, 0xffffffff
.long 0x1730100, 0x1848700, 0xffffffff, 0xffffffff, 0xffffffff, 0xffffffff, 0xffffffff, 0xffffffff
.long 0x1458800, 0xffffffff, 0xffffffff, 0xffffffff, 0xffffffff, 0xffffffff, 0xffffffff, 0xffffffff
.long 0x13e8400, 0xffffffff, 0xffffffff, 0xffffffff, 0xffffffff, 0xffffffff, 0xffffffff, 0xffffffff
.long 0xffffffff, 0xffffffff, 0xffffffff, 0xffffffff, 0xffffffff, 0xffffffff, 0xffffffff, 0xffffffff
.long 0x1689700, 0x14c9200, 0xffffffff, 0xffffffff, 0xffffffff, 0xffffffff, 0xffffffff, 0xffffffff
.long 0x15a9300, 0x1458e00, 0xffffffff, 0xffffffff, 0xffffffff, 0xffffffff, 0xffffffff, 0xffffffff
.long 0x14c8f00, 0x13e9900, 0xffffffff, 0xffffffff, 0xffffffff, 0xffffffff, 0xffffffff, 0xffffffff
.long 0x13e8b00, 0x1848d00, 0xffffffff, 0xffffffff, 0xffffffff, 0xffffffff, 0xffffffff, 0xffffffff
.long 0x1421100, 0x14c9800, 0xffffffff, 0xffffffff, 0xffffffff, 0xffffffff, 0xffffffff, 0xffffffff
.long 0x15a9a00, 0xffffffff, 0xffffffff, 0xffffffff, 0xffffffff, 0xffffffff, 0xffffffff, 0xffffffff
.long 0x1539600, 0xffffffff, 0xffffffff, 0xffffffff, 0xffffffff, 0xffffffff, 0xffffffff, 0xffffffff
```
